```python
import torch

def _softmax(x, axis=-1):
    return torch.softmax(x, dim=axis)
def _gelu(x):
    return torch.nn.functional.gelu(x, approximate="tanh")
def _silu(x):
    return torch.nn.functional.silu(x)
def _sigmoid(x):
    return torch.sigmoid(x)
def _layernorm(x, axis=-1, eps=1e-5):
    m = x.mean(dim=axis, keepdim=True)
    v = x.var(dim=axis, keepdim=True, unbiased=False)
    return (x - m) / torch.sqrt(v + eps)
def _scatter_add(tgt, idx, src, axis=0):
    return tgt.clone().index_add_(axis, idx, src)
def _segment_sum(src, seg, n):
    out = torch.zeros((n,) + src.shape[1:], dtype=src.dtype)
    return out.index_add_(0, seg, src)
def _pad(x, pw):
    flat = tuple(v for pair in reversed(pw) for v in pair)
    return torch.nn.functional.pad(x, flat)

kernel_name = 'standalone__edge_featured_mpnn_egc__graph'

def setup_inputs():

    _w = (lambda a: (lambda t: t.to(torch.bfloat16) if t.is_floating_point() else t)(torch.as_tensor(a)))
    N, deg, D, De = 25000, 32, 64, max(0, 1)
    E = N * deg
    return {
        "x": _w((lambda *s: torch.randn(*s, dtype=torch.bfloat16) * 0.2)(N, D)),
        "e_attr": _w((lambda *s: torch.randn(*s, dtype=torch.bfloat16) * 0.2)(E, De)),
        "src": _w((lambda lo, hi, *s: torch.randint(lo, hi, s))(0, N, E).to(torch.int64)),
        "dst": _w((lambda lo, hi, *s: torch.randint(lo, hi, s))(0, N, E).to(torch.int64)),
        "u_w": _w((lambda *s: torch.randn(*s, dtype=torch.bfloat16) * 0.05)(D, D)),
        "v_w": _w((lambda *s: torch.randn(*s, dtype=torch.bfloat16) * 0.05)(D, D)),
        "g_w": _w((lambda *s: torch.randn(*s, dtype=torch.bfloat16) * 0.2)(2 * D + De, D)),
    }

def reference(x, e_attr, src, dst, u_w, v_w, g_w):
    N, D = x.shape
    g_in = torch.concatenate([x[dst], x[src], e_attr], axis=-1)
    eta = _sigmoid(g_in @ g_w)
    hv = x @ v_w
    msg = eta * hv[src]
    agg = _segment_sum(msg, dst, N)
    return _silu(x @ u_w + agg)
```

```asm
; @launch kernel=egc_part_kernel grid=(250,1,1) block=(1024,1,1) lds=87360
; @launch kernel=standalone__edge_featured_mpnn_egc__graph_kernel grid=(250,1,1) block=(1024,1,1) lds=134912
    .amdgcn_target "amdgcn-amd-amdhsa--gfx950"
    .text
    .globl egc_part_kernel
    .p2align 8
    .type egc_part_kernel,@function
egc_part_kernel:
    s_cmp_ge_u32 s2, 250
    s_cbranch_scc1 L1_end
    s_load_dwordx16 s[4:19], s[0:1], 0
    s_load_dwordx2 s[20:21], s[0:1], 72
    s_and_b32 s24, s2, 7
    s_lshr_b32 s2, s2, 3
    s_mov_b32 s23, s2
    s_mul_i32 s25, s24, 31
    s_min_u32 s24, s24, 2
    s_add_u32 s2, s2, s25
    s_add_u32 s2, s2, s24
    v_and_b32 v1, 63, v0
    v_lshrrev_b32 v2, 6, v0
    v_lshlrev_b32 v3, 2, v0
    v_readfirstlane_b32 s22, v2
    v_mov_b32 v2, 0
    s_cmp_lt_u32 s22, 4
    s_cbranch_scc0 L1_nozero
    ds_write_b32 v3, v2 offset:0
L1_nozero:
    s_waitcnt lgkmcnt(0)
    s_cmp_lt_u32 s22, 8
    s_cselect_b32 s24, s16, s14
    s_cselect_b32 s25, s17, s15
    s_cselect_b32 s26, 8192, 0
    s_add_u32 s24, s24, s26
    s_addc_u32 s25, s25, 0
    v_and_b32 v100, 511, v0
    v_lshlrev_b32 v100, 4, v100
    global_load_dwordx4 v[16:19], v100, s[24:25]
    v_min_u32 v100, 799, v0
    v_lshlrev_b32 v100, 4, v100
    s_mul_i32 s26, s2, 12800
    v_add_u32 v100, s26, v100
    global_load_dwordx4 v[20:23], v100, s[4:5]
    s_barrier
    s_cmp_gt_u32 s22, 12
    s_cbranch_scc1 L1_noedge0
    s_mul_i32 s24, s2, 12800
    v_lshlrev_b32 v2, 4, v0
    v_add_u32 v2, s24, v2
    v_lshrrev_b32 v3, 1, v2
    v_cmp_gt_u32 vcc, 800, v0
    s_and_saveexec_b64 s[32:33], vcc
    global_load_dwordx4 v[4:7], v2, s[10:11]
    global_load_dwordx4 v[8:11], v2, s[8:9]
    global_load_dwordx2 v[12:13], v3, s[6:7]
    s_mov_b64 exec, s[32:33]
    s_waitcnt vmcnt(3)
    s_branch L1_wx
L1_noedge0:
    s_waitcnt vmcnt(0)
L1_wx:
    v_bfe_u32 v100, v0, 4, 1
    v_bfe_u32 v101, v0, 6, 1
    v_lshl_or_b32 v100, v101, 1, v100
    v_lshlrev_b32 v100, 5, v100
    v_lshlrev_b32 v101, 4, v0
    v_xor_b32 v100, v100, v101
    v_add_u32 v100, 2048, v100
    ds_write_b128 v100, v[16:19]
    v_lshrrev_b32 v100, 3, v0
    v_mul_u32_u24 v100, 144, v100
    v_and_b32 v101, 7, v0
    v_lshl_add_u32 v100, v101, 4, v100
    v_add_u32 v100, 18432, v100
    v_cmp_gt_u32 vcc, 800, v0
    s_and_saveexec_b64 s[32:33], vcc
    ds_write_b128 v100, v[20:23]
    s_mov_b64 exec, s[32:33]
    s_waitcnt lgkmcnt(0)
    s_barrier
    s_cmp_gt_u32 s22, 13
    s_cbranch_scc1 L1_notask
    s_and_b32 s27, s22, 1
    s_lshl_b32 s27, s27, 1
    s_lshr_b32 s26, s22, 1
    v_and_b32 v100, 15, v1
    v_lshrrev_b32 v101, 4, v1
    s_lshl_b32 s26, s26, 4
    v_add_u32 v87, s26, v100
    v_mul_u32_u24 v102, 144, v87
    v_lshl_add_u32 v102, v101, 4, v102
    v_add_u32 v102, 18432, v102
    ds_read_b128 v[24:27], v102
    ds_read_b128 v[28:31], v102 offset:64
    v_lshrrev_b32 v102, 3, v100
    v_and_b32 v32, 1, v101
    v_lshl_or_b32 v102, v32, 1, v102
    v_xor_b32 v102, s27, v102
    v_lshlrev_b32 v102, 5, v102
    v_lshrrev_b32 v32, 2, v100
    v_lshl_add_u32 v32, v101, 3, v32
    v_lshl_add_u32 v102, v32, 7, v102
    v_and_b32 v32, 3, v100
    v_lshl_add_u32 v102, v32, 3, v102
    v_add_u32 v102, 2048, v102
    ds_read_b64_tr_b16 v[36:37], v102 offset:0
    ds_read_b64_tr_b16 v[38:39], v102 offset:512
    ds_read_b64_tr_b16 v[40:41], v102 offset:4096
    ds_read_b64_tr_b16 v[42:43], v102 offset:4608
    ds_read_b64_tr_b16 v[44:45], v102 offset:8192
    ds_read_b64_tr_b16 v[46:47], v102 offset:8704
    ds_read_b64_tr_b16 v[48:49], v102 offset:12288
    ds_read_b64_tr_b16 v[50:51], v102 offset:12800
    s_waitcnt lgkmcnt(6)
    v_xor_b32 v102, 32, v102
    ds_read_b64_tr_b16 v[52:53], v102 offset:0
    ds_read_b64_tr_b16 v[54:55], v102 offset:512
    ds_read_b64_tr_b16 v[56:57], v102 offset:4096
    ds_read_b64_tr_b16 v[58:59], v102 offset:4608
    ds_read_b64_tr_b16 v[60:61], v102 offset:8192
    ds_read_b64_tr_b16 v[62:63], v102 offset:8704
    ds_read_b64_tr_b16 v[64:65], v102 offset:12288
    ds_read_b64_tr_b16 v[66:67], v102 offset:12800
    v_mul_u32_u24 v2, 272, v87
    v_lshrrev_b32 v3, 4, v1
    v_lshl_add_u32 v2, v3, 4, v2
    s_lshl_b32 s30, s27, 6
    s_add_u32 s30, s30, 34560
    v_add_u32 v2, s30, v2
    s_mov_b32 s24, 0xbfb8aa3b
    s_mov_b32 s25, 0x7fff0000
    s_mov_b32 s30, 0x7fffffff
    v_mov_b32 v33, 0xc77fe000
    v_mov_b32 v34, 0x477fe000
    v_cmp_gt_u32 vcc, 100, v87
    s_waitcnt lgkmcnt(0)
    v_mfma_f32_16x16x32_bf16 v[68:71], v[36:39], v[24:27], 0
    v_mfma_f32_16x16x32_bf16 v[72:75], v[44:47], v[24:27], 0
    v_mfma_f32_16x16x32_bf16 v[76:79], v[52:55], v[24:27], 0
    v_mfma_f32_16x16x32_bf16 v[80:83], v[60:63], v[24:27], 0
    v_mfma_f32_16x16x32_bf16 v[68:71], v[40:43], v[28:31], v[68:71]
    v_mfma_f32_16x16x32_bf16 v[72:75], v[48:51], v[28:31], v[72:75]
    v_mfma_f32_16x16x32_bf16 v[76:79], v[56:59], v[28:31], v[76:79]
    v_mfma_f32_16x16x32_bf16 v[80:83], v[64:67], v[28:31], v[80:83]
    s_nop 5
    v_mul_f32 v68, s24, v68
    v_mul_f32 v69, s24, v69
    v_mul_f32 v70, s24, v70
    v_mul_f32 v71, s24, v71
    v_med3_f32 v68, v68, v33, v34
    v_med3_f32 v69, v69, v33, v34
    v_med3_f32 v70, v70, v33, v34
    v_med3_f32 v71, v71, v33, v34
    v_cvt_pk_f16_f32 v84, v68, v69
    v_cvt_pk_f16_f32 v85, v70, v71
    v_and_b32 v68, s30, v72
    v_add_u32 v68, 0x8000, v68
    v_sub_u32_sdwa v68, v68, v84 clamp dst_sel:DWORD dst_unused:UNUSED_PAD src0_sel:DWORD src1_sel:WORD_0
    v_and_b32 v69, s30, v73
    v_add_u32 v69, 0x8000, v69
    v_sub_u32_sdwa v69, v69, v84 clamp dst_sel:DWORD dst_unused:UNUSED_PAD src0_sel:DWORD src1_sel:WORD_1
    v_and_b32 v70, s30, v74
    v_add_u32 v70, 0x8000, v70
    v_sub_u32_sdwa v70, v70, v85 clamp dst_sel:DWORD dst_unused:UNUSED_PAD src0_sel:DWORD src1_sel:WORD_0
    v_and_b32 v71, s30, v75
    v_add_u32 v71, 0x8000, v71
    v_sub_u32_sdwa v71, v71, v85 clamp dst_sel:DWORD dst_unused:UNUSED_PAD src0_sel:DWORD src1_sel:WORD_1
    v_bfi_b32 v72, s25, v68, v72
    v_bfi_b32 v73, s25, v69, v73
    v_bfi_b32 v74, s25, v70, v74
    v_bfi_b32 v75, s25, v71, v75
    v_mov_b32_sdwa v72, v84 dst_sel:WORD_0 dst_unused:UNUSED_PRESERVE src0_sel:WORD_0
    v_mov_b32_sdwa v73, v84 dst_sel:WORD_0 dst_unused:UNUSED_PRESERVE src0_sel:WORD_1
    v_mov_b32_sdwa v74, v85 dst_sel:WORD_0 dst_unused:UNUSED_PRESERVE src0_sel:WORD_0
    v_mov_b32_sdwa v75, v85 dst_sel:WORD_0 dst_unused:UNUSED_PRESERVE src0_sel:WORD_1
    s_and_saveexec_b64 s[32:33], vcc
    ds_write_b128 v2, v[72:75] offset:0
    s_mov_b64 exec, s[32:33]
    v_mul_f32 v76, s24, v76
    v_mul_f32 v77, s24, v77
    v_mul_f32 v78, s24, v78
    v_mul_f32 v79, s24, v79
    v_med3_f32 v76, v76, v33, v34
    v_med3_f32 v77, v77, v33, v34
    v_med3_f32 v78, v78, v33, v34
    v_med3_f32 v79, v79, v33, v34
    v_cvt_pk_f16_f32 v84, v76, v77
    v_cvt_pk_f16_f32 v85, v78, v79
    v_and_b32 v76, s30, v80
    v_add_u32 v76, 0x8000, v76
    v_sub_u32_sdwa v76, v76, v84 clamp dst_sel:DWORD dst_unused:UNUSED_PAD src0_sel:DWORD src1_sel:WORD_0
    v_and_b32 v77, s30, v81
    v_add_u32 v77, 0x8000, v77
    v_sub_u32_sdwa v77, v77, v84 clamp dst_sel:DWORD dst_unused:UNUSED_PAD src0_sel:DWORD src1_sel:WORD_1
    v_and_b32 v78, s30, v82
    v_add_u32 v78, 0x8000, v78
    v_sub_u32_sdwa v78, v78, v85 clamp dst_sel:DWORD dst_unused:UNUSED_PAD src0_sel:DWORD src1_sel:WORD_0
    v_and_b32 v79, s30, v83
    v_add_u32 v79, 0x8000, v79
    v_sub_u32_sdwa v79, v79, v85 clamp dst_sel:DWORD dst_unused:UNUSED_PAD src0_sel:DWORD src1_sel:WORD_1
    v_bfi_b32 v80, s25, v76, v80
    v_bfi_b32 v81, s25, v77, v81
    v_bfi_b32 v82, s25, v78, v82
    v_bfi_b32 v83, s25, v79, v83
    v_mov_b32_sdwa v80, v84 dst_sel:WORD_0 dst_unused:UNUSED_PRESERVE src0_sel:WORD_0
    v_mov_b32_sdwa v81, v84 dst_sel:WORD_0 dst_unused:UNUSED_PRESERVE src0_sel:WORD_1
    v_mov_b32_sdwa v82, v85 dst_sel:WORD_0 dst_unused:UNUSED_PRESERVE src0_sel:WORD_0
    v_mov_b32_sdwa v83, v85 dst_sel:WORD_0 dst_unused:UNUSED_PRESERVE src0_sel:WORD_1
    s_and_saveexec_b64 s[32:33], vcc
    ds_write_b128 v2, v[80:83] offset:64
    s_mov_b64 exec, s[32:33]
L1_notask:
    s_waitcnt lgkmcnt(0)
    s_barrier
    v_lshrrev_b32 v2, 4, v0
    v_mul_u32_u24 v2, 272, v2
    v_and_b32 v3, 15, v0
    v_lshl_add_u32 v2, v3, 4, v2
    v_add_u32 v2, 34560, v2
    ds_read_b128 v[16:19], v2
    s_mul_i32 s26, s2, 25600
    v_lshlrev_b32 v3, 4, v0
    v_add_u32 v3, s26, v3
    s_cmp_gt_u32 s22, 8
    s_cbranch_scc1 L1_t1
    ds_read_b128 v[20:23], v2 offset:17408
    v_add_u32 v14, 16384, v3
    s_waitcnt lgkmcnt(0)
    global_store_dwordx4 v14, v[20:23], s[20:21] nt
L1_t1:
    s_waitcnt lgkmcnt(0)
    global_store_dwordx4 v3, v[16:19], s[20:21] nt
    s_sub_u32 s24, s22, 13
    s_cmp_lt_u32 s24, 2
    s_cbranch_scc0 L1_not
    s_endpgm
L1_not:
    s_cmp_gt_u32 s22, 12
    s_cbranch_scc1 L1_noedge1
    v_cmp_gt_u32 vcc, 800, v0
    s_and_saveexec_b64 s[32:33], vcc
    v_mov_b32 v3, 1
    s_movk_i32 s24, -100
    s_mov_b32 s25, 0xffff0000
    s_movk_i32 s30, 128
    s_cmp_gt_u32 s22, 8
    s_cbranch_scc1 L1_w1
    s_waitcnt vmcnt(2)
    s_branch L1_w2
L1_w1:
    s_waitcnt vmcnt(1)
L1_w2:
    v_mul_u32_u24 v2, 5243, v4
    v_lshrrev_b32 v2, 19, v2
    v_lshlrev_b32 v88, 2, v2
    ds_add_rtn_u32 v92, v88, v3 offset:0
    v_mad_i32_i24 v14, v2, s24, v4
    v_lshrrev_b32 v15, 5, v8
    v_and_or_b32 v105, v15, s30, v14
    v_lshl_or_b32 v104, v12, 16, v8
    v_mul_u32_u24 v2, 5243, v5
    v_lshrrev_b32 v2, 19, v2
    v_lshlrev_b32 v89, 2, v2
    ds_add_rtn_u32 v93, v89, v3 offset:0
    v_mad_i32_i24 v14, v2, s24, v5
    v_lshrrev_b32 v15, 5, v9
    v_and_or_b32 v107, v15, s30, v14
    v_and_or_b32 v106, v12, s25, v9
    v_mul_u32_u24 v2, 5243, v6
    v_lshrrev_b32 v2, 19, v2
    v_lshlrev_b32 v90, 2, v2
    ds_add_rtn_u32 v94, v90, v3 offset:0
    v_mad_i32_i24 v14, v2, s24, v6
    v_lshrrev_b32 v15, 5, v10
    v_and_or_b32 v109, v15, s30, v14
    v_lshl_or_b32 v108, v13, 16, v10
    v_mul_u32_u24 v2, 5243, v7
    v_lshrrev_b32 v2, 19, v2
    v_lshlrev_b32 v91, 2, v2
    ds_add_rtn_u32 v95, v91, v3 offset:0
    v_mad_i32_i24 v14, v2, s24, v7
    v_lshrrev_b32 v15, 5, v11
    v_and_or_b32 v111, v15, s30, v14
    v_and_or_b32 v110, v13, s25, v11
    s_mov_b64 exec, s[32:33]
L1_noedge1:
    s_waitcnt lgkmcnt(0)
    s_barrier
    s_cmp_eq_u32 s22, 15
    s_cbranch_scc0 L1_b2
    v_lshlrev_b32 v2, 4, v1
    ds_read_b128 v[24:27], v2 offset:0
    s_waitcnt lgkmcnt(0)
    v_add_u32 v30, v24, v25
    v_add_u32 v31, v30, v26
    v_add_u32 v32, v31, v27
    v_mov_b32 v33, v32
    s_nop 1
    v_add_u32_dpp v33, v33, v33 row_shr:1 row_mask:0xf bank_mask:0xf bound_ctrl:0
    s_nop 1
    v_add_u32_dpp v33, v33, v33 row_shr:2 row_mask:0xf bank_mask:0xf bound_ctrl:0
    s_nop 1
    v_add_u32_dpp v33, v33, v33 row_shr:4 row_mask:0xf bank_mask:0xf bound_ctrl:0
    s_nop 1
    v_add_u32_dpp v33, v33, v33 row_shr:8 row_mask:0xf bank_mask:0xf bound_ctrl:0
    s_nop 1
    v_add_u32_dpp v33, v33, v33 row_bcast:15 row_mask:0xa bank_mask:0xf
    s_nop 1
    v_add_u32_dpp v33, v33, v33 row_bcast:31 row_mask:0xc bank_mask:0xf
    s_nop 1
    v_sub_u32 v28, v33, v32
    v_add_u32 v29, v28, v24
    v_add_u32 v30, v28, v30
    v_add_u32 v31, v28, v31
    ds_write_b128 v2, v[28:31] offset:1024
    s_lshl_b32 s24, s2, 10
    s_add_u32 s24, s24, 14680064
    v_add_u32 v3, s24, v2
    v_lshl_or_b32 v36, v24, 16, v28
    v_lshl_or_b32 v37, v25, 16, v29
    v_lshl_or_b32 v38, v26, 16, v30
    v_lshl_or_b32 v39, v27, 16, v31
    global_store_dwordx4 v3, v[36:39], s[20:21]
    s_cmp_lg_u32 s2, 0
    s_cbranch_scc1 L1_b2
    v_mov_b32 v14, 0
    v_lshlrev_b32 v15, 2, v1
    v_add_u32 v15, 6400000, v15
    global_store_dword v15, v14, s[20:21]
L1_b2:
    s_waitcnt lgkmcnt(0)
    s_barrier
    s_cmp_gt_u32 s22, 12
    s_cbranch_scc1 L1_noedge2
    v_cmp_gt_u32 vcc, 800, v0
    s_and_saveexec_b64 s[32:33], vcc
    ds_read_b32 v4, v88 offset:1024
    ds_read_b32 v5, v89 offset:1024
    ds_read_b32 v6, v90 offset:1024
    ds_read_b32 v7, v91 offset:1024
    s_mov_b32 s24, 61760
    s_waitcnt lgkmcnt(3)
    v_add_u32 v4, v4, v92
    v_lshl_add_u32 v4, v4, 3, s24
    ds_write_b64 v4, v[104:105]
    s_waitcnt lgkmcnt(3)
    v_add_u32 v5, v5, v93
    v_lshl_add_u32 v5, v5, 3, s24
    ds_write_b64 v5, v[106:107]
    s_waitcnt lgkmcnt(3)
    v_add_u32 v6, v6, v94
    v_lshl_add_u32 v6, v6, 3, s24
    ds_write_b64 v6, v[108:109]
    s_waitcnt lgkmcnt(3)
    v_add_u32 v7, v7, v95
    v_lshl_add_u32 v7, v7, 3, s24
    ds_write_b64 v7, v[110:111]
    s_mov_b64 exec, s[32:33]
L1_noedge2:
    s_min_u32 s25, s22, 13
    s_lshl_b32 s25, s25, 10
    v_lshlrev_b32 v2, 4, v1
    v_add_u32 v2, s25, v2
    v_add_u32 v3, 61760, v2
    s_mul_i32 s24, s2, 25600
    s_add_u32 s24, s24, 7340032
    v_add_u32 v2, s24, v2
    s_waitcnt lgkmcnt(0)
    s_barrier
    ds_read_b128 v[24:27], v3
    s_cmp_gt_u32 s22, 10
    s_cbranch_scc1 L1_oner
    ds_read_b128 v[28:31], v3 offset:14336
    v_add_u32 v3, 14336, v2
    s_waitcnt lgkmcnt(0)
    global_store_dwordx4 v3, v[28:31], s[20:21]
L1_oner:
    s_waitcnt lgkmcnt(0)
    global_store_dwordx4 v2, v[24:27], s[20:21]
L1_end:
    s_endpgm
    .globl standalone__edge_featured_mpnn_egc__graph_kernel
    .p2align 8
    .type standalone__edge_featured_mpnn_egc__graph_kernel,@function
standalone__edge_featured_mpnn_egc__graph_kernel:
    s_cmp_ge_u32 s2, 250
    s_cbranch_scc1 L2_end
    s_load_dwordx16 s[4:19], s[0:1], 0
    s_load_dwordx2 s[20:21], s[0:1], 72
    s_and_b32 s24, s2, 7
    s_lshr_b32 s2, s2, 3
    s_mov_b32 s23, s2
    s_mul_i32 s25, s24, 31
    s_min_u32 s24, s24, 2
    s_add_u32 s2, s2, s25
    s_add_u32 s2, s2, s24
    v_and_b32 v1, 63, v0
    v_lshrrev_b32 v2, 6, v0
    v_lshlrev_b32 v3, 2, v0
    v_readfirstlane_b32 s22, v2
    v_lshrrev_b32 v6, 2, v0
    v_lshlrev_b32 v6, 10, v6
    s_lshl_b32 s24, s2, 2
    s_add_u32 s24, s24, 14680064
    v_add_u32 v6, s24, v6
    s_waitcnt lgkmcnt(0)
    global_load_dword v7, v6, s[20:21]
    s_barrier
    s_cmp_lt_u32 s22, 8
    s_cselect_b32 s24, s16, s12
    s_cselect_b32 s25, s17, s13
    v_and_b32 v100, 511, v0
    v_lshlrev_b32 v100, 4, v100
    global_load_dwordx4 v[32:35], v100, s[24:25]
    v_min_u32 v100, 799, v0
    v_lshlrev_b32 v100, 4, v100
    s_mul_i32 s26, s2, 12800
    v_add_u32 v100, s26, v100
    global_load_dwordx4 v[36:39], v100, s[4:5]
    v_and_b32 v2, 15, v1
    v_lshlrev_b32 v116, 4, v2
    v_lshrrev_b32 v4, 1, v116
    v_add_u32 v4, 16384, v4
    global_load_dwordx2 v[122:123], v4, s[16:17]
    v_mov_b32 v2, 0
    s_cmp_lt_u32 s22, 4
    s_cbranch_scc0 L2_nozero
    ds_write_b32 v3, v2 offset:0
    ds_write_b32 v3, v2 offset:1024
L2_nozero:
    s_cmp_eq_u32 s22, 4
    s_cbranch_scc0 L2_nozero2
    v_lshlrev_b32 v4, 2, v1
    v_cmp_eq_u32 vcc, 2, v1
    s_nop 1
    v_cndmask_b32 v5, 0, 16, vcc
    ds_write_b32 v4, v5 offset:5120
    ds_write_b32 v4, v2 offset:5632
L2_nozero2:
    v_mov_b32 v40, 25000
    v_mov_b32 v41, 25000
    v_mov_b32 v42, 25000
    v_mov_b32 v43, 25000
    v_lshlrev_b32 v4, 4, v0
    v_add_u32 v4, 91072, v4
    ds_write_b128 v4, v[40:43]
    ds_write_b128 v4, v[40:43] offset:16384
    v_cmp_gt_u32 vcc, 688, v0
    s_and_saveexec_b64 s[32:33], vcc
    ds_write_b128 v4, v[40:43] offset:32768
    s_mov_b64 exec, s[32:33]
    v_mov_b32 v119, 1
    v_mov_b32 v103, 91072
    v_bfe_u32 v100, v0, 4, 1
    v_bfe_u32 v102, v0, 6, 1
    v_lshl_or_b32 v100, v102, 1, v100
    v_lshlrev_b32 v100, 5, v100
    v_lshlrev_b32 v102, 4, v0
    v_xor_b32 v100, v100, v102
    v_add_u32 v100, 60288, v100
    v_lshrrev_b32 v101, 3, v0
    v_mul_u32_u24 v101, 144, v101
    v_and_b32 v102, 7, v0
    v_lshl_add_u32 v101, v102, 4, v101
    v_add_u32 v101, 76672, v101
    s_and_b32 s27, s22, 3
    s_lshr_b32 s26, s22, 2
    s_lshl_b32 s26, s26, 5
    v_and_b32 v2, 15, v1
    v_lshrrev_b32 v3, 4, v1
    v_add_u32 v4, s26, v2
    v_mul_u32_u24 v104, 144, v4
    v_lshl_add_u32 v104, v3, 4, v104
    v_add_u32 v104, 76672, v104
    v_mul_u32_u24 v106, 272, v4
    v_lshl_add_u32 v106, v3, 4, v106
    s_lshl_b32 s30, s27, 6
    v_add_u32 v106, s30, v106
    v_lshrrev_b32 v4, 3, v2
    v_and_b32 v5, 1, v3
    v_lshl_or_b32 v4, v5, 1, v4
    v_xor_b32 v4, s27, v4
    v_lshlrev_b32 v4, 5, v4
    v_lshrrev_b32 v5, 2, v2
    v_lshl_add_u32 v5, v3, 3, v5
    v_lshl_add_u32 v4, v5, 7, v4
    v_and_b32 v5, 3, v2
    v_lshl_add_u32 v4, v5, 3, v4
    v_add_u32 v105, 60288, v4
    v_mov_b32 v107, 0xc2700000
    v_cmp_gt_u32 s[34:35], 4, v2
    v_lshrrev_b32 v6, 2, v0
    v_mul_u32_u24 v6, 3200, v6
    v_and_b32 v5, 3, v0
    v_lshlrev_b32 v5, 1, v5
    v_add_u32 v6, v6, v5
    v_lshlrev_b32 v6, 3, v6
    v_add_u32 v6, 7340032, v6
    v_cmp_gt_u32 vcc, 1000, v0
    s_waitcnt vmcnt(3)
    v_cndmask_b32 v7, 0, v7, vcc
    v_and_b32 v4, 0xffff, v7
    v_lshrrev_b32 v7, 16, v7
    v_lshl_add_u32 v6, v4, 3, v6
    v_cmp_lt_u32 s[56:57], 40, v7
    v_sub_u32 v7, v7, v5
    v_cmp_gt_i32 s[40:41], v7, 0
    v_cmp_gt_i32 s[44:45], v7, 8
    v_cmp_gt_i32 s[48:49], v7, 16
    v_cmp_gt_i32 s[52:53], v7, 24
    v_cmp_gt_i32 s[60:61], v7, 32
    s_nop 1
    s_mov_b32 s58, 0
    s_mov_b64 exec, s[40:41]
    s_cbranch_execz L2_recs_done
    global_load_dwordx4 v[8:11], v6, s[20:21] offset:0
    s_mov_b32 s58, 1
    s_mov_b64 exec, s[44:45]
    s_cbranch_execz L2_recs_done
    global_load_dwordx4 v[12:15], v6, s[20:21] offset:64
    s_mov_b32 s58, 2
    s_mov_b64 exec, s[48:49]
    s_cbranch_execz L2_recs_done
    global_load_dwordx4 v[16:19], v6, s[20:21] offset:128
    s_mov_b32 s58, 3
    s_mov_b64 exec, s[52:53]
    s_cbranch_execz L2_recs_done
    global_load_dwordx4 v[20:23], v6, s[20:21] offset:192
    s_mov_b32 s58, 4
    s_mov_b64 exec, s[60:61]
    s_cbranch_execz L2_recs_done
    global_load_dwordx4 v[72:75], v6, s[20:21] offset:256
    s_mov_b32 s58, 5
L2_recs_done:
    s_mov_b64 exec, -1
    s_cmp_lt_u32 s22, 12
    s_cbranch_scc1 L2_notouche
    s_sub_u32 s25, s22, 12
    s_cmp_gt_u32 s25, 3
    s_cbranch_scc1 L2_notouche
    s_lshl_b32 s25, s25, 6
    v_add_u32 v4, s25, v1
    v_min_u32 v4, 199, v4
    v_lshlrev_b32 v4, 7, v4
    s_mul_i32 s24, s2, 25600
    v_add_u32 v4, s24, v4
    global_load_dword v126, v4, s[20:21]
    s_add_u32 s58, s58, 1
L2_notouche:
    v_cmp_gt_i32 s[42:43], v7, 1
    v_cmp_gt_i32 s[46:47], v7, 9
    v_cmp_gt_i32 s[50:51], v7, 17
    v_cmp_gt_i32 s[54:55], v7, 25
    v_cmp_gt_i32 s[62:63], v7, 33
    s_cmp_lg_u32 s58, 6
    s_cbranch_scc1 L2_wx6
    s_waitcnt vmcnt(6)
    s_branch L2_wxdone
L2_wx6:
    s_cmp_lg_u32 s58, 5
    s_cbranch_scc1 L2_wx5
    s_waitcnt vmcnt(5)
    s_branch L2_wxdone
L2_wx5:
    s_cmp_lg_u32 s58, 4
    s_cbranch_scc1 L2_wx4
    s_waitcnt vmcnt(4)
    s_branch L2_wxdone
L2_wx4:
    s_cmp_lg_u32 s58, 3
    s_cbranch_scc1 L2_wx3
    s_waitcnt vmcnt(3)
    s_branch L2_wxdone
L2_wx3:
    s_cmp_lg_u32 s58, 2
    s_cbranch_scc1 L2_wx2
    s_waitcnt vmcnt(2)
    s_branch L2_wxdone
L2_wx2:
    s_cmp_lg_u32 s58, 1
    s_cbranch_scc1 L2_wx1
    s_waitcnt vmcnt(1)
    s_branch L2_wxdone
L2_wx1:
    s_waitcnt vmcnt(0)
L2_wxdone:
    ds_write_b128 v100, v[32:35]
    v_cmp_gt_u32 vcc, 800, v0
    s_and_saveexec_b64 s[32:33], vcc
    ds_write_b128 v101, v[36:39]
    s_mov_b64 exec, s[32:33]
    s_mov_b32 s24, 0xbfb8aa3b
    v_lshlrev_b32 v120, 16, v122
    v_and_b32 v121, 0xffff0000, v122
    v_lshlrev_b32 v122, 16, v123
    v_and_b32 v123, 0xffff0000, v123
    v_mul_f32 v120, s24, v120
    v_mul_f32 v121, s24, v121
    v_mul_f32 v122, s24, v122
    v_mul_f32 v123, s24, v123
    s_waitcnt lgkmcnt(0)
    s_barrier
    s_cmp_eq_u64 s[56:57], 0
    s_cbranch_scc1 L2_noflag
    v_mov_b32 v4, 0
    ds_write_b32 v4, v119 offset:5120
L2_noflag:
    s_cmp_gt_u32 s22, 11
    s_cbranch_scc1 L2_pu_last
    ds_read_b128 v[48:51], v104
    ds_read_b128 v[52:55], v104 offset:64
    ds_read_b64_tr_b16 v[32:33], v105 offset:0
    ds_read_b64_tr_b16 v[34:35], v105 offset:512
    ds_read_b64_tr_b16 v[36:37], v105 offset:4096
    ds_read_b64_tr_b16 v[38:39], v105 offset:4608
    ds_read_b64_tr_b16 v[40:41], v105 offset:8192
    ds_read_b64_tr_b16 v[42:43], v105 offset:8704
    ds_read_b64_tr_b16 v[44:45], v105 offset:12288
    ds_read_b64_tr_b16 v[46:47], v105 offset:12800
    ds_read_b128 v[56:59], v104 offset:2304
    ds_read_b128 v[60:63], v104 offset:2368
    s_mov_b32 s24, 0xbfb8aa3b
    s_waitcnt lgkmcnt(2)
    v_mfma_f32_16x16x32_bf16 v[64:67], v[32:35], v[48:51], 0
    v_mfma_f32_16x16x32_bf16 v[68:71], v[40:43], v[48:51], 0
    v_mfma_f32_16x16x32_bf16 v[64:67], v[36:39], v[52:55], v[64:67]
    v_mfma_f32_16x16x32_bf16 v[68:71], v[44:47], v[52:55], v[68:71]
    s_waitcnt lgkmcnt(0)
    v_mfma_f32_16x16x32_bf16 v[48:51], v[32:35], v[56:59], 0
    v_mfma_f32_16x16x32_bf16 v[52:55], v[40:43], v[56:59], 0
    v_mfma_f32_16x16x32_bf16 v[48:51], v[36:39], v[60:63], v[48:51]
    v_mfma_f32_16x16x32_bf16 v[52:55], v[44:47], v[60:63], v[52:55]
    s_nop 3
    v_fma_f32 v64, v64, s24, v107
    v_fma_f32 v65, v65, s24, v107
    v_fma_f32 v66, v66, s24, v107
    v_fma_f32 v67, v67, s24, v107
    ds_write_b128 v106, v[64:67] offset:5888
    ds_write_b128 v106, v[68:71] offset:33088
    v_fma_f32 v48, v48, s24, v107
    v_fma_f32 v49, v49, s24, v107
    v_fma_f32 v50, v50, s24, v107
    v_fma_f32 v51, v51, s24, v107
    ds_write_b128 v106, v[48:51] offset:10240
    ds_write_b128 v106, v[52:55] offset:37440
    s_branch L2_pu_end
L2_pu_last:
    ds_read_b128 v[48:51], v104
    ds_read_b128 v[52:55], v104 offset:64
    ds_read_b64_tr_b16 v[32:33], v105 offset:0
    ds_read_b64_tr_b16 v[34:35], v105 offset:512
    ds_read_b64_tr_b16 v[36:37], v105 offset:4096
    ds_read_b64_tr_b16 v[38:39], v105 offset:4608
    ds_read_b64_tr_b16 v[40:41], v105 offset:8192
    ds_read_b64_tr_b16 v[42:43], v105 offset:8704
    ds_read_b64_tr_b16 v[44:45], v105 offset:12288
    ds_read_b64_tr_b16 v[46:47], v105 offset:12800
    s_mov_b32 s24, 0xbfb8aa3b
    s_waitcnt lgkmcnt(0)
    v_mfma_f32_16x16x32_bf16 v[64:67], v[32:35], v[48:51], 0
    v_mfma_f32_16x16x32_bf16 v[68:71], v[40:43], v[48:51], 0
    v_mfma_f32_16x16x32_bf16 v[64:67], v[36:39], v[52:55], v[64:67]
    v_mfma_f32_16x16x32_bf16 v[68:71], v[44:47], v[52:55], v[68:71]
    s_mov_b64 exec, s[34:35]
    s_nop 6
    v_fma_f32 v64, v64, s24, v107
    v_fma_f32 v65, v65, s24, v107
    v_fma_f32 v66, v66, s24, v107
    v_fma_f32 v67, v67, s24, v107
    ds_write_b128 v106, v[64:67] offset:5888
    ds_write_b128 v106, v[68:71] offset:33088
    s_mov_b64 exec, -1
L2_pu_end:
    v_and_b32 v2, 15, v1
    v_lshrrev_b32 v3, 4, v1
    v_lshlrev_b32 v117, 2, v3
    s_mul_i32 s24, s2, 12800
    v_lshrrev_b32 v124, 1, v116
    v_add_u32 v124, s24, v124
    v_lshlrev_b32 v118, 2, v1
    v_add_u32 v118, 5376, v118
    v_cmp_eq_u32 vcc, 0, v1
    v_mov_b32 v5, 5128
    v_lshrrev_b32 v4, 2, v2
    v_cndmask_b32 v118, v118, v5, vcc
    v_cmp_eq_u32 vcc, v4, v3
    v_mov_b32 v5, 0x3c00
    v_and_b32 v4, 3, v2
    v_cndmask_b32 v5, 0, v5, vcc
    v_cmp_eq_u32 vcc, 0, v4
    s_nop 1
    v_cndmask_b32 v112, 0, v5, vcc
    v_cmp_eq_u32 vcc, 1, v4
    s_nop 1
    v_cndmask_b32 v113, 0, v5, vcc
    v_cmp_eq_u32 vcc, 2, v4
    s_nop 1
    v_cndmask_b32 v114, 0, v5, vcc
    v_cmp_eq_u32 vcc, 3, v4
    s_nop 1
    v_cndmask_b32 v115, 0, v5, vcc
    s_mov_b32 s36, s20
    s_and_b32 s37, s21, 0xffff
    s_or_b32 s37, s37, 0x1000000
    s_mov_b32 s38, 25001
    s_mov_b32 s39, 0x20000
    s_mov_b32 s66, 0x21800000
    s_mov_b32 s67, 0x21800000
    v_mov_b32 v77, v116
    v_mov_b32 v79, v116
    v_mov_b32 v92, 0
    v_mov_b32 v93, 0
    v_mov_b32 v81, v116
    v_mov_b32 v83, v116
    v_mov_b32 v94, 0
    v_mov_b32 v95, 0
    v_mov_b32 v85, v116
    v_mov_b32 v87, v116
    v_mov_b32 v96, 0
    v_mov_b32 v97, 0
    v_mov_b32 v89, v116
    v_mov_b32 v91, v116
    v_mov_b32 v98, 0
    v_mov_b32 v99, 0
    s_movk_i32 s59, 192
    s_sub_u32 s24, s22, 12
    s_cmp_lt_u32 s24, 4
    s_cbranch_scc0 L2_wall
    s_waitcnt vmcnt(1)
    s_branch L2_wall2
L2_wall:
    s_waitcnt vmcnt(0)
L2_wall2:
    s_mov_b64 exec, s[40:41]
    v_lshlrev_b32 v3, 2, v9
    ds_add_rtn_u32 v24, v3, v119 offset:0
    v_mad_u32_u24 v9, v9, s59, v103
    s_mov_b64 exec, s[42:43]
    v_lshlrev_b32 v3, 2, v11
    ds_add_rtn_u32 v25, v3, v119 offset:0
    v_mad_u32_u24 v11, v11, s59, v103
    s_mov_b64 exec, s[44:45]
    v_lshlrev_b32 v3, 2, v13
    ds_add_rtn_u32 v26, v3, v119 offset:0
    v_mad_u32_u24 v13, v13, s59, v103
    s_mov_b64 exec, s[46:47]
    v_lshlrev_b32 v3, 2, v15
    ds_add_rtn_u32 v27, v3, v119 offset:0
    v_mad_u32_u24 v15, v15, s59, v103
    s_cmp_eq_u64 s[48:49], 0
    s_cbranch_scc1 L2_hdone
    s_mov_b64 exec, s[48:49]
    v_lshlrev_b32 v3, 2, v17
    ds_add_rtn_u32 v28, v3, v119 offset:0
    v_mad_u32_u24 v17, v17, s59, v103
    s_mov_b64 exec, s[50:51]
    v_lshlrev_b32 v3, 2, v19
    ds_add_rtn_u32 v29, v3, v119 offset:0
    v_mad_u32_u24 v19, v19, s59, v103
    s_cmp_eq_u64 s[52:53], 0
    s_cbranch_scc1 L2_hdone
    s_mov_b64 exec, s[52:53]
    v_lshlrev_b32 v3, 2, v21
    ds_add_rtn_u32 v30, v3, v119 offset:0
    v_mad_u32_u24 v21, v21, s59, v103
    s_mov_b64 exec, s[54:55]
    v_lshlrev_b32 v3, 2, v23
    ds_add_rtn_u32 v31, v3, v119 offset:0
    v_mad_u32_u24 v23, v23, s59, v103
    s_cmp_eq_u64 s[60:61], 0
    s_cbranch_scc1 L2_hdone
    s_mov_b64 exec, s[60:61]
    v_lshlrev_b32 v3, 2, v73
    ds_add_rtn_u32 v100, v3, v119 offset:0
    v_mad_u32_u24 v73, v73, s59, v103
    s_mov_b64 exec, s[62:63]
    v_lshlrev_b32 v3, 2, v75
    ds_add_rtn_u32 v101, v3, v119 offset:0
    v_mad_u32_u24 v75, v75, s59, v103
L2_hdone:
    s_mov_b64 exec, -1
    s_waitcnt lgkmcnt(0)
    s_mov_b64 exec, s[40:41]
    v_min_u32 v24, 63, v24
    v_lshl_add_u32 v9, v24, 2, v9
    ds_write_b32 v9, v8
    s_mov_b64 exec, s[42:43]
    v_min_u32 v25, 63, v25
    v_lshl_add_u32 v11, v25, 2, v11
    ds_write_b32 v11, v10
    s_mov_b64 exec, s[44:45]
    v_min_u32 v26, 63, v26
    v_lshl_add_u32 v13, v26, 2, v13
    ds_write_b32 v13, v12
    s_mov_b64 exec, s[46:47]
    v_min_u32 v27, 63, v27
    v_lshl_add_u32 v15, v27, 2, v15
    ds_write_b32 v15, v14
    s_cmp_eq_u64 s[48:49], 0
    s_cbranch_scc1 L2_sdone
    s_mov_b64 exec, s[48:49]
    v_min_u32 v28, 63, v28
    v_lshl_add_u32 v17, v28, 2, v17
    ds_write_b32 v17, v16
    s_mov_b64 exec, s[50:51]
    v_min_u32 v29, 63, v29
    v_lshl_add_u32 v19, v29, 2, v19
    ds_write_b32 v19, v18
    s_cmp_eq_u64 s[52:53], 0
    s_cbranch_scc1 L2_sdone
    s_mov_b64 exec, s[52:53]
    v_min_u32 v30, 63, v30
    v_lshl_add_u32 v21, v30, 2, v21
    ds_write_b32 v21, v20
    s_mov_b64 exec, s[54:55]
    v_min_u32 v31, 63, v31
    v_lshl_add_u32 v23, v31, 2, v23
    ds_write_b32 v23, v22
    s_cmp_eq_u64 s[60:61], 0
    s_cbranch_scc1 L2_sdone
    s_mov_b64 exec, s[60:61]
    v_min_u32 v100, 63, v100
    v_lshl_add_u32 v73, v100, 2, v73
    ds_write_b32 v73, v72
    s_mov_b64 exec, s[62:63]
    v_min_u32 v101, 63, v101
    v_lshl_add_u32 v75, v101, 2, v75
    ds_write_b32 v75, v74
L2_sdone:
    s_mov_b64 exec, -1
    s_waitcnt lgkmcnt(0)
    s_barrier
    s_cmp_eq_u32 s22, 15
    s_cbranch_scc0 L2_b2
L2_order:
    s_setprio 3
    v_lshlrev_b32 v2, 4, v1
    ds_read_b128 v[64:67], v2 offset:0
    v_lshrrev_b32 v3, 5, v1
    v_and_b32 v4, 31, v1
    v_cmp_gt_u32 vcc, 25, v4
    v_lshlrev_b32 v5, 8, v3
    v_add_u32 v5, 252, v5
    v_mov_b32 v56, 764
    v_cndmask_b32 v5, v56, v5, vcc
    v_lshlrev_b32 v4, 2, v4
    v_mul_u32_u24 v3, 768, v1
    v_lshl_or_b32 v3, v3, 16, v4
    s_waitcnt lgkmcnt(0)
    v_max3_u32 v57, v64, v65, v66
    v_max_u32 v57, v57, v67
    v_min_u32 v68, 63, v64
    v_lshlrev_b32 v68, 2, v68
    v_sub_u32 v68, v5, v68
    ds_add_rtn_u32 v72, v68, v119 offset:1024
    v_min_u32 v69, 63, v65
    v_lshlrev_b32 v69, 2, v69
    v_sub_u32 v69, v5, v69
    ds_add_rtn_u32 v73, v69, v119 offset:1024
    v_min_u32 v70, 63, v66
    v_lshlrev_b32 v70, 2, v70
    v_sub_u32 v70, v5, v70
    ds_add_rtn_u32 v74, v70, v119 offset:1024
    v_min_u32 v71, 63, v67
    v_lshlrev_b32 v71, 2, v71
    v_sub_u32 v71, v5, v71
    ds_add_rtn_u32 v75, v71, v119 offset:1024
    ds_read_b128 v[60:63], v2 offset:1024
    v_cmp_lt_u32 vcc, 48, v57
    s_cbranch_vccz L2_nocap
    v_mov_b32 v56, 0
    ds_write_b32 v56, v119 offset:5120
L2_nocap:
    s_waitcnt lgkmcnt(0)
    v_add_u32 v57, v60, v61
    v_add_u32 v58, v57, v62
    v_add_u32 v59, v58, v63
    v_mov_b32 v56, v59
    s_nop 1
    v_add_u32_dpp v56, v56, v56 row_shr:1 row_mask:0xf bank_mask:0xf bound_ctrl:0
    s_nop 1
    v_add_u32_dpp v56, v56, v56 row_shr:2 row_mask:0xf bank_mask:0xf bound_ctrl:0
    s_nop 1
    v_add_u32_dpp v56, v56, v56 row_shr:4 row_mask:0xf bank_mask:0xf bound_ctrl:0
    s_nop 1
    v_add_u32_dpp v56, v56, v56 row_shr:8 row_mask:0xf bank_mask:0xf bound_ctrl:0
    s_nop 1
    v_add_u32_dpp v56, v56, v56 row_bcast:15 row_mask:0xa bank_mask:0xf
    s_nop 1
    v_add_u32_dpp v56, v56, v56 row_bcast:31 row_mask:0xc bank_mask:0xf
    s_nop 1
    v_sub_u32 v56, v56, v59
    v_add_u32 v59, v56, v58
    v_add_u32 v58, v56, v57
    v_add_u32 v57, v56, v60
    ds_write_b128 v2, v[56:59] offset:2048
    ds_read_b32 v60, v68 offset:2048
    ds_read_b32 v61, v69 offset:2048
    ds_read_b32 v62, v70 offset:2048
    ds_read_b32 v63, v71 offset:2048
    s_waitcnt lgkmcnt(0)
    v_add_u32 v72, v72, v60
    v_lshlrev_b32 v72, 2, v72
    v_add_u32 v56, 0, v3
    ds_write_b32 v72, v64 offset:3072
    ds_write_b32 v72, v56 offset:4096
    v_add_u32 v73, v73, v61
    v_lshlrev_b32 v73, 2, v73
    v_add_u32 v56, 12582913, v3
    ds_write_b32 v73, v65 offset:3072
    ds_write_b32 v73, v56 offset:4096
    v_add_u32 v74, v74, v62
    v_lshlrev_b32 v74, 2, v74
    v_add_u32 v56, 25165826, v3
    ds_write_b32 v74, v66 offset:3072
    ds_write_b32 v74, v56 offset:4096
    v_add_u32 v75, v75, v63
    v_lshlrev_b32 v75, 2, v75
    v_add_u32 v56, 37748739, v3
    ds_write_b32 v75, v67 offset:3072
    ds_write_b32 v75, v56 offset:4096
    s_setprio 0
L2_b2:
    s_waitcnt lgkmcnt(0)
    s_barrier
    s_setprio 3
    s_movk_i32 s68, 272
    v_mov_b32 v2, 0
    ds_read_b32 v3, v2 offset:5120
    v_lshlrev_b32 v4, 4, v1
    ds_read_b32 v125, v4 offset:3072
    s_lshl_b32 s26, s22, 4
    v_add_u32 v4, s26, v117
    ds_read_b32 v5, v4 offset:4096
    s_waitcnt lgkmcnt(0)
    v_readfirstlane_b32 s24, v3
    v_max_u32 v125, 8, v125
    v_lshrrev_b32 v100, 16, v5
    v_add_u32 v100, 91072, v100
    s_cmp_lg_u32 s24, 0
    s_cbranch_scc1 L2_slow
    ds_read_u16 v76, v100 offset:0
    ds_read_u16 v78, v100 offset:4
    ds_read_u16 v80, v100 offset:8
    ds_read_u16 v82, v100 offset:12
    ds_read_u16 v84, v100 offset:16
    ds_read_u16 v86, v100 offset:20
    ds_read_u16 v88, v100 offset:24
    ds_read_u16 v90, v100 offset:28
    v_and_b32 v103, 0xffff, v5
    v_mad_u32_u24 v103, v103, s68, v116
    v_mov_b32 v101, v103
    s_mov_b32 s58, 0
    s_mov_b32 s59, 0
    s_mov_b32 s28, 0xbfb8aa3b
    s_mov_b32 s29, 0xbfb8aa3b
    s_mov_b32 s30, 1.0
    s_mov_b32 s31, 1.0
    v_readlane_b32 s62, v125, s22
    s_mov_b32 s64, 4
    s_mov_b32 s63, s22
    s_mov_b32 s57, 0
    s_and_b32 s69, s62, 1
    s_add_u32 s61, s62, 1
    s_lshr_b32 s61, s61, 1
    s_waitcnt lgkmcnt(0)
    buffer_load_dwordx4 v[44:47], v[76:77], s[36:39], 0 idxen offen
    buffer_load_dwordx4 v[48:51], v[78:79], s[36:39], 0 idxen offen
    buffer_load_dwordx4 v[52:55], v[80:81], s[36:39], 0 idxen offen
    buffer_load_dwordx4 v[56:59], v[82:83], s[36:39], 0 idxen offen
    buffer_load_dwordx4 v[60:63], v[84:85], s[36:39], 0 idxen offen
    buffer_load_dwordx4 v[64:67], v[86:87], s[36:39], 0 idxen offen
    ds_read_u16_d16_hi v92, v100 offset:2
    ds_read_u16_d16_hi v93, v100 offset:6
    ds_read_u16_d16_hi v94, v100 offset:10
    ds_read_u16_d16_hi v95, v100 offset:14
    ds_read_u16_d16_hi v96, v100 offset:18
    ds_read_u16_d16_hi v97, v100 offset:22
    ds_read_u16_d16_hi v98, v100 offset:26
    ds_read_u16_d16_hi v99, v100 offset:30
    ds_read_b128 v[8:11], v103 offset:5888
    ds_read_b128 v[16:19], v103 offset:33088
    v_mov_b32 v12, 0
    v_mov_b32 v13, 0
    v_mov_b32 v14, 0
    v_mov_b32 v15, 0
    s_setprio 2
    s_waitcnt lgkmcnt(0)
    s_cmp_eq_u32 s61, s64
    s_cbranch_scc1 L2_pop_first
L2_first_cont:
    s_waitcnt vmcnt(4)
    v_mfma_f32_16x16x32_f16 v[28:31], v[112:115], v[44:47], v[8:11]
    v_mfma_f32_16x16x32_f16 v[32:35], v[112:115], v[48:51], v[8:11]
    ds_read_u16 v76, v100 offset:32
    ds_read_u16 v78, v100 offset:36
    s_nop 2
    buffer_load_dwordx4 v[68:71], v[88:89], s[36:39], 0 idxen offen
    buffer_load_dwordx4 v[72:75], v[90:91], s[36:39], 0 idxen offen
    s_branch L2_mid0
L2_loop:
L2_top0:
    s_cmp_eq_u32 s61, s64
    s_cbranch_scc1 L2_ev0
L2_cont0:
    v_pk_mul_f32 v[20:21], v[36:37], v[40:41]
    v_pk_mul_f32 v[22:23], v[38:39], v[42:43]
    v_pk_mul_f32 v[24:25], v[68:69], v[40:41]
    v_pk_mul_f32 v[26:27], v[70:71], v[42:43]
    v_pk_fma_f32 v[24:25], v[72:73], v[36:37], v[24:25]
    v_pk_fma_f32 v[26:27], v[74:75], v[38:39], v[26:27]
    s_waitcnt vmcnt(4)
    v_mfma_f32_16x16x32_f16 v[28:31], v[112:115], v[44:47], v[8:11]
    v_rcp_f32 v20, v20
    v_rcp_f32 v21, v21
    v_mfma_f32_16x16x32_f16 v[32:35], v[112:115], v[48:51], v[8:11]
    v_rcp_f32 v22, v22
    v_rcp_f32 v23, v23
    ds_read_u16 v76, v100 offset:32
    ds_read_u16 v78, v100 offset:36
    v_pk_fma_f32 v[12:13], v[24:25], v[20:21], v[12:13]
    v_pk_fma_f32 v[14:15], v[26:27], v[22:23], v[14:15]
    s_waitcnt lgkmcnt(4)
    buffer_load_dwordx4 v[68:71], v[88:89], s[36:39], 0 idxen offen
    buffer_load_dwordx4 v[72:75], v[90:91], s[36:39], 0 idxen offen
L2_mid0:
    v_pk_fma_f32 v[28:29], v[92:93], v[120:121], v[28:29] op_sel_hi:[0,1,1]
    v_pk_fma_f32 v[30:31], v[92:93], v[122:123], v[30:31] op_sel_hi:[0,1,1]
    v_pk_fma_f32 v[32:33], v[92:93], v[120:121], v[32:33] op_sel:[1,0,0] op_sel_hi:[1,1,1]
    v_pk_fma_f32 v[34:35], v[92:93], v[122:123], v[34:35] op_sel:[1,0,0] op_sel_hi:[1,1,1]
    ds_read_u16_d16_hi v92, v100 offset:34
    ds_read_u16_d16_hi v93, v100 offset:38
    v_exp_f32_e64 v28, v28 clamp
    v_exp_f32_e64 v29, v29 clamp
    v_exp_f32_e64 v30, v30 clamp
    v_exp_f32_e64 v31, v31 clamp
    v_exp_f32_e64 v32, v32 clamp
    v_exp_f32_e64 v33, v33 clamp
    v_pk_add_f32 v[28:29], v[28:29], s[66:67]
    v_exp_f32_e64 v34, v34 clamp
    v_exp_f32_e64 v35, v35 clamp
    v_pk_add_f32 v[30:31], v[30:31], s[66:67]
    v_pk_add_f32 v[32:33], v[32:33], s[66:67]
    v_pk_add_f32 v[34:35], v[34:35], s[66:67]
    s_sub_u32 s61, s61, 1
L2_top1:
    s_cmp_eq_u32 s61, s64
    s_cbranch_scc1 L2_ev1
L2_cont1:
    v_pk_mul_f32 v[20:21], v[28:29], v[32:33]
    v_pk_mul_f32 v[22:23], v[30:31], v[34:35]
    v_pk_mul_f32 v[24:25], v[44:45], v[32:33]
    v_pk_mul_f32 v[26:27], v[46:47], v[34:35]
    v_pk_fma_f32 v[24:25], v[48:49], v[28:29], v[24:25]
    v_pk_fma_f32 v[26:27], v[50:51], v[30:31], v[26:27]
    s_waitcnt vmcnt(4)
    v_mfma_f32_16x16x32_f16 v[36:39], v[112:115], v[52:55], v[8:11]
    v_rcp_f32 v20, v20
    v_rcp_f32 v21, v21
    v_mfma_f32_16x16x32_f16 v[40:43], v[112:115], v[56:59], v[8:11]
    v_rcp_f32 v22, v22
    v_rcp_f32 v23, v23
    ds_read_u16 v80, v100 offset:40
    ds_read_u16 v82, v100 offset:44
    v_pk_fma_f32 v[12:13], v[24:25], v[20:21], v[12:13]
    v_pk_fma_f32 v[14:15], v[26:27], v[22:23], v[14:15]
    s_waitcnt lgkmcnt(4)
    buffer_load_dwordx4 v[44:47], v[76:77], s[36:39], 0 idxen offen
    buffer_load_dwordx4 v[48:51], v[78:79], s[36:39], 0 idxen offen
L2_mid1:
    v_pk_fma_f32 v[36:37], v[94:95], v[120:121], v[36:37] op_sel_hi:[0,1,1]
    v_pk_fma_f32 v[38:39], v[94:95], v[122:123], v[38:39] op_sel_hi:[0,1,1]
    v_pk_fma_f32 v[40:41], v[94:95], v[120:121], v[40:41] op_sel:[1,0,0] op_sel_hi:[1,1,1]
    v_pk_fma_f32 v[42:43], v[94:95], v[122:123], v[42:43] op_sel:[1,0,0] op_sel_hi:[1,1,1]
    ds_read_u16_d16_hi v94, v100 offset:42
    ds_read_u16_d16_hi v95, v100 offset:46
    v_exp_f32_e64 v36, v36 clamp
    v_exp_f32_e64 v37, v37 clamp
    v_exp_f32_e64 v38, v38 clamp
    v_exp_f32_e64 v39, v39 clamp
    v_exp_f32_e64 v40, v40 clamp
    v_exp_f32_e64 v41, v41 clamp
    v_pk_add_f32 v[36:37], v[36:37], s[66:67]
    v_exp_f32_e64 v42, v42 clamp
    v_exp_f32_e64 v43, v43 clamp
    v_pk_add_f32 v[38:39], v[38:39], s[66:67]
    v_pk_add_f32 v[40:41], v[40:41], s[66:67]
    v_pk_add_f32 v[42:43], v[42:43], s[66:67]
    s_sub_u32 s61, s61, 1
L2_top2:
    s_cmp_eq_u32 s61, s64
    s_cbranch_scc1 L2_ev2
L2_cont2:
    v_pk_mul_f32 v[20:21], v[36:37], v[40:41]
    v_pk_mul_f32 v[22:23], v[38:39], v[42:43]
    v_pk_mul_f32 v[24:25], v[52:53], v[40:41]
    v_pk_mul_f32 v[26:27], v[54:55], v[42:43]
    v_pk_fma_f32 v[24:25], v[56:57], v[36:37], v[24:25]
    v_pk_fma_f32 v[26:27], v[58:59], v[38:39], v[26:27]
    s_waitcnt vmcnt(4)
    v_mfma_f32_16x16x32_f16 v[28:31], v[112:115], v[60:63], v[8:11]
    v_rcp_f32 v20, v20
    v_rcp_f32 v21, v21
    v_mfma_f32_16x16x32_f16 v[32:35], v[112:115], v[64:67], v[8:11]
    v_rcp_f32 v22, v22
    v_rcp_f32 v23, v23
    ds_read_u16 v84, v100 offset:48
    ds_read_u16 v86, v100 offset:52
    v_pk_fma_f32 v[12:13], v[24:25], v[20:21], v[12:13]
    v_pk_fma_f32 v[14:15], v[26:27], v[22:23], v[14:15]
    s_waitcnt lgkmcnt(4)
    buffer_load_dwordx4 v[52:55], v[80:81], s[36:39], 0 idxen offen
    buffer_load_dwordx4 v[56:59], v[82:83], s[36:39], 0 idxen offen
L2_mid2:
    v_pk_fma_f32 v[28:29], v[96:97], v[120:121], v[28:29] op_sel_hi:[0,1,1]
    v_pk_fma_f32 v[30:31], v[96:97], v[122:123], v[30:31] op_sel_hi:[0,1,1]
    v_pk_fma_f32 v[32:33], v[96:97], v[120:121], v[32:33] op_sel:[1,0,0] op_sel_hi:[1,1,1]
    v_pk_fma_f32 v[34:35], v[96:97], v[122:123], v[34:35] op_sel:[1,0,0] op_sel_hi:[1,1,1]
    ds_read_u16_d16_hi v96, v100 offset:50
    ds_read_u16_d16_hi v97, v100 offset:54
    v_exp_f32_e64 v28, v28 clamp
    v_exp_f32_e64 v29, v29 clamp
    v_exp_f32_e64 v30, v30 clamp
    v_exp_f32_e64 v31, v31 clamp
    v_exp_f32_e64 v32, v32 clamp
    v_exp_f32_e64 v33, v33 clamp
    v_pk_add_f32 v[28:29], v[28:29], s[66:67]
    v_exp_f32_e64 v34, v34 clamp
    v_exp_f32_e64 v35, v35 clamp
    v_pk_add_f32 v[30:31], v[30:31], s[66:67]
    v_pk_add_f32 v[32:33], v[32:33], s[66:67]
    v_pk_add_f32 v[34:35], v[34:35], s[66:67]
    s_sub_u32 s61, s61, 1
L2_top3:
    s_cmp_eq_u32 s61, s64
    s_cbranch_scc1 L2_ev3
L2_cont3:
    v_pk_mul_f32 v[20:21], v[28:29], v[32:33]
    v_pk_mul_f32 v[22:23], v[30:31], v[34:35]
    v_pk_mul_f32 v[24:25], v[60:61], v[32:33]
    v_pk_mul_f32 v[26:27], v[62:63], v[34:35]
    v_pk_fma_f32 v[24:25], v[64:65], v[28:29], v[24:25]
    v_pk_fma_f32 v[26:27], v[66:67], v[30:31], v[26:27]
    s_waitcnt vmcnt(4)
    v_mfma_f32_16x16x32_f16 v[36:39], v[112:115], v[68:71], v[8:11]
    v_rcp_f32 v20, v20
    v_rcp_f32 v21, v21
    v_mfma_f32_16x16x32_f16 v[40:43], v[112:115], v[72:75], v[8:11]
    v_rcp_f32 v22, v22
    v_rcp_f32 v23, v23
    ds_read_u16 v88, v100 offset:56
    ds_read_u16 v90, v100 offset:60
    v_pk_fma_f32 v[12:13], v[24:25], v[20:21], v[12:13]
    v_pk_fma_f32 v[14:15], v[26:27], v[22:23], v[14:15]
    s_waitcnt lgkmcnt(4)
    buffer_load_dwordx4 v[60:63], v[84:85], s[36:39], 0 idxen offen
    buffer_load_dwordx4 v[64:67], v[86:87], s[36:39], 0 idxen offen
L2_mid3:
    v_pk_fma_f32 v[36:37], v[98:99], v[120:121], v[36:37] op_sel_hi:[0,1,1]
    v_pk_fma_f32 v[38:39], v[98:99], v[122:123], v[38:39] op_sel_hi:[0,1,1]
    v_pk_fma_f32 v[40:41], v[98:99], v[120:121], v[40:41] op_sel:[1,0,0] op_sel_hi:[1,1,1]
    v_pk_fma_f32 v[42:43], v[98:99], v[122:123], v[42:43] op_sel:[1,0,0] op_sel_hi:[1,1,1]
    ds_read_u16_d16_hi v98, v100 offset:58
    ds_read_u16_d16_hi v99, v100 offset:62
    v_exp_f32_e64 v36, v36 clamp
    v_exp_f32_e64 v37, v37 clamp
    v_exp_f32_e64 v38, v38 clamp
    v_exp_f32_e64 v39, v39 clamp
    v_exp_f32_e64 v40, v40 clamp
    v_exp_f32_e64 v41, v41 clamp
    v_pk_add_f32 v[36:37], v[36:37], s[66:67]
    v_exp_f32_e64 v42, v42 clamp
    v_exp_f32_e64 v43, v43 clamp
    v_pk_add_f32 v[38:39], v[38:39], s[66:67]
    v_pk_add_f32 v[40:41], v[40:41], s[66:67]
    v_pk_add_f32 v[42:43], v[42:43], s[66:67]
    s_sub_u32 s61, s61, 1
    v_add_u32 v100, 32, v100
    s_branch L2_loop
L2_pop_first:
    ds_add_rtn_u32 v4, v118, v119
    s_mov_b32 s64, s69
    s_waitcnt lgkmcnt(0)
    v_readfirstlane_b32 s63, v4
    s_mov_b32 s62, 0
    v_mov_b32 v100, 110240
    s_nop 1
    s_cmp_lt_u32 s63, 50
    s_cbranch_scc0 L2_first_cont
    s_lshl_b32 s26, s63, 4
    v_add_u32 v4, s26, v117
    ds_read_b32 v5, v4 offset:4096
    v_readlane_b32 s62, v125, s63
    s_waitcnt lgkmcnt(0)
    v_and_b32 v103, 0xffff, v5
    v_lshrrev_b32 v100, 16, v5
    v_lshl_add_u32 v105, v103, 7, v124
    v_mad_u32_u24 v103, v103, s68, v116
    v_add_u32 v100, 91040, v100
    s_branch L2_first_cont
L2_ev0:
    s_cmp_eq_u32 s64, 0
    s_cbranch_scc1 L2_sw0
    s_cmp_eq_u32 s64, 1
    s_cbranch_scc1 L2_half0
    ds_add_rtn_u32 v4, v118, v119
    s_mov_b32 s64, s69
    s_waitcnt lgkmcnt(0)
    v_readfirstlane_b32 s63, v4
    s_mov_b32 s62, 0
    v_mov_b32 v100, 110240
    s_nop 1
    s_cmp_lt_u32 s63, 50
    s_cbranch_scc0 L2_cont0
    s_lshl_b32 s26, s63, 4
    v_add_u32 v4, s26, v117
    ds_read_b32 v5, v4 offset:4096
    v_readlane_b32 s62, v125, s63
    s_waitcnt lgkmcnt(0)
    v_and_b32 v103, 0xffff, v5
    v_lshrrev_b32 v100, 16, v5
    v_lshl_add_u32 v105, v103, 7, v124
    v_mad_u32_u24 v103, v103, s68, v116
    v_add_u32 v100, 91040, v100
    s_branch L2_cont0
L2_half0:
    v_pk_mul_f32 v[20:21], v[36:37], v[40:41]
    v_pk_mul_f32 v[22:23], v[38:39], v[42:43]
    v_pk_mul_f32 v[24:25], v[68:69], v[40:41]
    v_pk_mul_f32 v[26:27], v[70:71], v[42:43]
    v_pk_fma_f32 v[24:25], v[72:73], v[36:37], v[24:25]
    v_pk_fma_f32 v[26:27], v[74:75], v[38:39], v[26:27]
    s_waitcnt vmcnt(4)
    v_mfma_f32_16x16x32_f16 v[28:31], v[112:115], v[44:47], v[8:11]
    v_rcp_f32 v20, v20
    v_rcp_f32 v21, v21
    v_rcp_f32 v22, v22
    v_rcp_f32 v23, v23
    ds_read_u16 v76, v100 offset:32
    ds_read_u16 v78, v100 offset:36
    v_pk_fma_f32 v[12:13], v[24:25], v[20:21], v[12:13]
    v_pk_fma_f32 v[14:15], v[26:27], v[22:23], v[14:15]
    s_waitcnt lgkmcnt(4)
    buffer_load_dwordx4 v[68:71], v[88:89], s[36:39], 0 idxen offen
    buffer_load_dwordx4 v[72:75], v[90:91], s[36:39], 0 idxen offen
    v_pk_fma_f32 v[28:29], v[92:93], v[120:121], v[28:29] op_sel_hi:[0,1,1]
    v_pk_fma_f32 v[30:31], v[92:93], v[122:123], v[30:31] op_sel_hi:[0,1,1]
    ds_read_u16_d16_hi v92, v100 offset:34
    ds_read_u16_d16_hi v93, v100 offset:38
    v_exp_f32_e64 v28, v28 clamp
    v_exp_f32_e64 v29, v29 clamp
    v_exp_f32_e64 v30, v30 clamp
    v_exp_f32_e64 v31, v31 clamp
    v_pk_add_f32 v[28:29], v[28:29], s[66:67]
    v_pk_add_f32 v[30:31], v[30:31], s[66:67]
    s_mov_b32 s61, 0
    s_mov_b32 s64, 0
    s_mov_b32 s57, 1
    s_branch L2_top1
L2_sw0:
    s_cmp_lg_u32 s57, 0
    s_cbranch_scc1 L2_swh0
    v_pk_mul_f32 v[20:21], v[36:37], v[40:41]
    v_pk_mul_f32 v[22:23], v[38:39], v[42:43]
    v_pk_mul_f32 v[24:25], v[68:69], v[40:41]
    v_pk_mul_f32 v[26:27], v[70:71], v[42:43]
    v_pk_fma_f32 v[24:25], v[72:73], v[36:37], v[24:25]
    v_pk_fma_f32 v[26:27], v[74:75], v[38:39], v[26:27]
    v_rcp_f32 v20, v20
    v_rcp_f32 v21, v21
    v_rcp_f32 v22, v22
    v_rcp_f32 v23, v23
    s_nop 0
    v_pk_fma_f32 v[12:13], v[24:25], v[20:21], v[12:13]
    v_pk_fma_f32 v[14:15], v[26:27], v[22:23], v[14:15]
    s_branch L2_swf0
L2_swh0:
    v_rcp_f32 v36, v36
    v_rcp_f32 v37, v37
    v_rcp_f32 v38, v38
    v_rcp_f32 v39, v39
    s_mov_b32 s57, 0
    v_pk_fma_f32 v[12:13], v[36:37], v[68:69], v[12:13]
    v_pk_fma_f32 v[14:15], v[38:39], v[70:71], v[14:15]
L2_swf0:
    s_cmp_lg_u32 s58, 0
    s_cbranch_scc1 L2_fin0
    v_pk_fma_f32 v[16:17], v[12:13], s[66:67], v[16:17]
    v_pk_fma_f32 v[18:19], v[14:15], s[66:67], v[18:19]
    ds_write_b128 v101, v[16:19] offset:33088
    ds_add_u32 v118, v119 offset:4
    s_branch L2_fld0
L2_fin0:
    s_cmp_lg_u32 s59, 0
    s_cbranch_scc1 L2_rdy0
    s_mov_b32 s25, 0
L2_spin0:
    v_mov_b32 v4, 0
    ds_read_b32 v4, v4 offset:5132
    s_waitcnt lgkmcnt(0)
    v_readfirstlane_b32 s24, v4
    s_nop 3
    s_cmp_ge_u32 s24, 25
    s_cbranch_scc1 L2_seen0
    s_sleep 2
    s_add_u32 s25, s25, 1
    s_cmp_lt_u32 s25, 0x400000
    s_cbranch_scc1 L2_spin0
L2_seen0:
    s_mov_b32 s59, 1
L2_rdy0:
    ds_read_b128 v[16:19], v101 offset:33088
    s_waitcnt lgkmcnt(0)
    v_pk_fma_f32 v[16:17], v[12:13], s[66:67], v[16:17]
    v_pk_fma_f32 v[18:19], v[14:15], s[66:67], v[18:19]
    v_pk_mul_f32 v[20:21], v[16:17], s[28:29]
    v_pk_mul_f32 v[22:23], v[18:19], s[28:29]
    v_exp_f32 v20, v20
    v_exp_f32 v21, v21
    v_exp_f32 v22, v22
    v_exp_f32 v23, v23
    v_pk_add_f32 v[20:21], v[20:21], s[30:31]
    v_pk_add_f32 v[22:23], v[22:23], s[30:31]
    v_rcp_f32 v20, v20
    v_rcp_f32 v21, v21
    v_rcp_f32 v22, v22
    v_rcp_f32 v23, v23
    v_pk_mul_f32 v[16:17], v[16:17], v[20:21]
    v_pk_mul_f32 v[18:19], v[18:19], v[22:23]
    v_cvt_pk_bf16_f32 v24, v16, v17
    v_cvt_pk_bf16_f32 v25, v18, v19
    global_store_dwordx2 v104, v[24:25], s[18:19] nt
L2_fld0:
    s_cmp_eq_u32 s62, 0
    s_cbranch_scc1 L2_exit
    ds_read_b128 v[8:11], v103 offset:5888
    ds_read_b128 v[16:19], v103 offset:33088
    v_mov_b32 v12, 0
    v_mov_b32 v13, 0
    v_mov_b32 v14, 0
    v_mov_b32 v15, 0
    v_mov_b32 v101, v103
    v_mov_b32 v104, v105
    s_cmp_ge_u32 s63, 25
    s_cselect_b32 s58, 1, 0
    s_and_b32 s69, s62, 1
    s_add_u32 s61, s62, 1
    s_lshr_b32 s61, s61, 1
    s_mov_b32 s64, 4
    s_cmp_lt_u32 s63, 38
    s_cbranch_scc1 L2_p1_0
    s_setprio 0
    s_branch L2_pd_0
L2_p1_0:
    s_cmp_lt_u32 s63, 25
    s_cbranch_scc1 L2_pd_0
    s_setprio 1
L2_pd_0:
    s_cmp_eq_u32 s61, 4
    s_cbranch_scc0 L2_sw2_0
    ds_add_rtn_u32 v4, v118, v119
    s_mov_b32 s64, s69
    s_waitcnt lgkmcnt(0)
    v_readfirstlane_b32 s63, v4
    s_mov_b32 s62, 0
    v_mov_b32 v100, 110240
    s_nop 1
    s_cmp_lt_u32 s63, 50
    s_cbranch_scc0 L2_sw2_0
    s_lshl_b32 s26, s63, 4
    v_add_u32 v4, s26, v117
    ds_read_b32 v5, v4 offset:4096
    v_readlane_b32 s62, v125, s63
    s_waitcnt lgkmcnt(0)
    v_and_b32 v103, 0xffff, v5
    v_lshrrev_b32 v100, 16, v5
    v_lshl_add_u32 v105, v103, 7, v124
    v_mad_u32_u24 v103, v103, s68, v116
    v_add_u32 v100, 91040, v100
    s_branch L2_sw2_0
L2_sw2_0:
    s_waitcnt vmcnt(4) lgkmcnt(0)
    v_mfma_f32_16x16x32_f16 v[28:31], v[112:115], v[44:47], v[8:11]
    v_mfma_f32_16x16x32_f16 v[32:35], v[112:115], v[48:51], v[8:11]
    ds_read_u16 v76, v100 offset:32
    ds_read_u16 v78, v100 offset:36
    s_nop 2
    buffer_load_dwordx4 v[68:71], v[88:89], s[36:39], 0 idxen offen
    buffer_load_dwordx4 v[72:75], v[90:91], s[36:39], 0 idxen offen
    s_branch L2_mid0
L2_ev1:
    s_cmp_eq_u32 s64, 0
    s_cbranch_scc1 L2_sw1
    s_cmp_eq_u32 s64, 1
    s_cbranch_scc1 L2_half1
    ds_add_rtn_u32 v4, v118, v119
    s_mov_b32 s64, s69
    s_waitcnt lgkmcnt(0)
    v_readfirstlane_b32 s63, v4
    s_mov_b32 s62, 0
    v_mov_b32 v100, 110232
    s_nop 1
    s_cmp_lt_u32 s63, 50
    s_cbranch_scc0 L2_cont1
    s_lshl_b32 s26, s63, 4
    v_add_u32 v4, s26, v117
    ds_read_b32 v5, v4 offset:4096
    v_readlane_b32 s62, v125, s63
    s_waitcnt lgkmcnt(0)
    v_and_b32 v103, 0xffff, v5
    v_lshrrev_b32 v100, 16, v5
    v_lshl_add_u32 v105, v103, 7, v124
    v_mad_u32_u24 v103, v103, s68, v116
    v_add_u32 v100, 91032, v100
    s_branch L2_cont1
L2_half1:
    v_pk_mul_f32 v[20:21], v[28:29], v[32:33]
    v_pk_mul_f32 v[22:23], v[30:31], v[34:35]
    v_pk_mul_f32 v[24:25], v[44:45], v[32:33]
    v_pk_mul_f32 v[26:27], v[46:47], v[34:35]
    v_pk_fma_f32 v[24:25], v[48:49], v[28:29], v[24:25]
    v_pk_fma_f32 v[26:27], v[50:51], v[30:31], v[26:27]
    s_waitcnt vmcnt(4)
    v_mfma_f32_16x16x32_f16 v[36:39], v[112:115], v[52:55], v[8:11]
    v_rcp_f32 v20, v20
    v_rcp_f32 v21, v21
    v_rcp_f32 v22, v22
    v_rcp_f32 v23, v23
    ds_read_u16 v80, v100 offset:40
    ds_read_u16 v82, v100 offset:44
    v_pk_fma_f32 v[12:13], v[24:25], v[20:21], v[12:13]
    v_pk_fma_f32 v[14:15], v[26:27], v[22:23], v[14:15]
    s_waitcnt lgkmcnt(4)
    buffer_load_dwordx4 v[44:47], v[76:77], s[36:39], 0 idxen offen
    buffer_load_dwordx4 v[48:51], v[78:79], s[36:39], 0 idxen offen
    v_pk_fma_f32 v[36:37], v[94:95], v[120:121], v[36:37] op_sel_hi:[0,1,1]
    v_pk_fma_f32 v[38:39], v[94:95], v[122:123], v[38:39] op_sel_hi:[0,1,1]
    ds_read_u16_d16_hi v94, v100 offset:42
    ds_read_u16_d16_hi v95, v100 offset:46
    v_exp_f32_e64 v36, v36 clamp
    v_exp_f32_e64 v37, v37 clamp
    v_exp_f32_e64 v38, v38 clamp
    v_exp_f32_e64 v39, v39 clamp
    v_pk_add_f32 v[36:37], v[36:37], s[66:67]
    v_pk_add_f32 v[38:39], v[38:39], s[66:67]
    s_mov_b32 s61, 0
    s_mov_b32 s64, 0
    s_mov_b32 s57, 1
    s_branch L2_top2
L2_sw1:
    s_cmp_lg_u32 s57, 0
    s_cbranch_scc1 L2_swh1
    v_pk_mul_f32 v[20:21], v[28:29], v[32:33]
    v_pk_mul_f32 v[22:23], v[30:31], v[34:35]
    v_pk_mul_f32 v[24:25], v[44:45], v[32:33]
    v_pk_mul_f32 v[26:27], v[46:47], v[34:35]
    v_pk_fma_f32 v[24:25], v[48:49], v[28:29], v[24:25]
    v_pk_fma_f32 v[26:27], v[50:51], v[30:31], v[26:27]
    v_rcp_f32 v20, v20
    v_rcp_f32 v21, v21
    v_rcp_f32 v22, v22
    v_rcp_f32 v23, v23
    s_nop 0
    v_pk_fma_f32 v[12:13], v[24:25], v[20:21], v[12:13]
    v_pk_fma_f32 v[14:15], v[26:27], v[22:23], v[14:15]
    s_branch L2_swf1
L2_swh1:
    v_rcp_f32 v28, v28
    v_rcp_f32 v29, v29
    v_rcp_f32 v30, v30
    v_rcp_f32 v31, v31
    s_mov_b32 s57, 0
    v_pk_fma_f32 v[12:13], v[28:29], v[44:45], v[12:13]
    v_pk_fma_f32 v[14:15], v[30:31], v[46:47], v[14:15]
L2_swf1:
    s_cmp_lg_u32 s58, 0
    s_cbranch_scc1 L2_fin1
    v_pk_fma_f32 v[16:17], v[12:13], s[66:67], v[16:17]
    v_pk_fma_f32 v[18:19], v[14:15], s[66:67], v[18:19]
    ds_write_b128 v101, v[16:19] offset:33088
    ds_add_u32 v118, v119 offset:4
    s_branch L2_fld1
L2_fin1:
    s_cmp_lg_u32 s59, 0
    s_cbranch_scc1 L2_rdy1
    s_mov_b32 s25, 0
L2_spin1:
    v_mov_b32 v4, 0
    ds_read_b32 v4, v4 offset:5132
    s_waitcnt lgkmcnt(0)
    v_readfirstlane_b32 s24, v4
    s_nop 3
    s_cmp_ge_u32 s24, 25
    s_cbranch_scc1 L2_seen1
    s_sleep 2
    s_add_u32 s25, s25, 1
    s_cmp_lt_u32 s25, 0x400000
    s_cbranch_scc1 L2_spin1
L2_seen1:
    s_mov_b32 s59, 1
L2_rdy1:
    ds_read_b128 v[16:19], v101 offset:33088
    s_waitcnt lgkmcnt(0)
    v_pk_fma_f32 v[16:17], v[12:13], s[66:67], v[16:17]
    v_pk_fma_f32 v[18:19], v[14:15], s[66:67], v[18:19]
    v_pk_mul_f32 v[20:21], v[16:17], s[28:29]
    v_pk_mul_f32 v[22:23], v[18:19], s[28:29]
    v_exp_f32 v20, v20
    v_exp_f32 v21, v21
    v_exp_f32 v22, v22
    v_exp_f32 v23, v23
    v_pk_add_f32 v[20:21], v[20:21], s[30:31]
    v_pk_add_f32 v[22:23], v[22:23], s[30:31]
    v_rcp_f32 v20, v20
    v_rcp_f32 v21, v21
    v_rcp_f32 v22, v22
    v_rcp_f32 v23, v23
    v_pk_mul_f32 v[16:17], v[16:17], v[20:21]
    v_pk_mul_f32 v[18:19], v[18:19], v[22:23]
    v_cvt_pk_bf16_f32 v24, v16, v17
    v_cvt_pk_bf16_f32 v25, v18, v19
    global_store_dwordx2 v104, v[24:25], s[18:19] nt
L2_fld1:
    s_cmp_eq_u32 s62, 0
    s_cbranch_scc1 L2_exit
    ds_read_b128 v[8:11], v103 offset:5888
    ds_read_b128 v[16:19], v103 offset:33088
    v_mov_b32 v12, 0
    v_mov_b32 v13, 0
    v_mov_b32 v14, 0
    v_mov_b32 v15, 0
    v_mov_b32 v101, v103
    v_mov_b32 v104, v105
    s_cmp_ge_u32 s63, 25
    s_cselect_b32 s58, 1, 0
    s_and_b32 s69, s62, 1
    s_add_u32 s61, s62, 1
    s_lshr_b32 s61, s61, 1
    s_mov_b32 s64, 4
    s_cmp_lt_u32 s63, 38
    s_cbranch_scc1 L2_p1_1
    s_setprio 0
    s_branch L2_pd_1
L2_p1_1:
    s_cmp_lt_u32 s63, 25
    s_cbranch_scc1 L2_pd_1
    s_setprio 1
L2_pd_1:
    s_cmp_eq_u32 s61, 4
    s_cbranch_scc0 L2_sw2_1
    ds_add_rtn_u32 v4, v118, v119
    s_mov_b32 s64, s69
    s_waitcnt lgkmcnt(0)
    v_readfirstlane_b32 s63, v4
    s_mov_b32 s62, 0
    v_mov_b32 v100, 110232
    s_nop 1
    s_cmp_lt_u32 s63, 50
    s_cbranch_scc0 L2_sw2_1
    s_lshl_b32 s26, s63, 4
    v_add_u32 v4, s26, v117
    ds_read_b32 v5, v4 offset:4096
    v_readlane_b32 s62, v125, s63
    s_waitcnt lgkmcnt(0)
    v_and_b32 v103, 0xffff, v5
    v_lshrrev_b32 v100, 16, v5
    v_lshl_add_u32 v105, v103, 7, v124
    v_mad_u32_u24 v103, v103, s68, v116
    v_add_u32 v100, 91032, v100
    s_branch L2_sw2_1
L2_sw2_1:
    s_waitcnt vmcnt(4) lgkmcnt(0)
    v_mfma_f32_16x16x32_f16 v[36:39], v[112:115], v[52:55], v[8:11]
    v_mfma_f32_16x16x32_f16 v[40:43], v[112:115], v[56:59], v[8:11]
    ds_read_u16 v80, v100 offset:40
    ds_read_u16 v82, v100 offset:44
    s_nop 2
    buffer_load_dwordx4 v[44:47], v[76:77], s[36:39], 0 idxen offen
    buffer_load_dwordx4 v[48:51], v[78:79], s[36:39], 0 idxen offen
    s_branch L2_mid1
L2_ev2:
    s_cmp_eq_u32 s64, 0
    s_cbranch_scc1 L2_sw2
    s_cmp_eq_u32 s64, 1
    s_cbranch_scc1 L2_half2
    ds_add_rtn_u32 v4, v118, v119
    s_mov_b32 s64, s69
    s_waitcnt lgkmcnt(0)
    v_readfirstlane_b32 s63, v4
    s_mov_b32 s62, 0
    v_mov_b32 v100, 110224
    s_nop 1
    s_cmp_lt_u32 s63, 50
    s_cbranch_scc0 L2_cont2
    s_lshl_b32 s26, s63, 4
    v_add_u32 v4, s26, v117
    ds_read_b32 v5, v4 offset:4096
    v_readlane_b32 s62, v125, s63
    s_waitcnt lgkmcnt(0)
    v_and_b32 v103, 0xffff, v5
    v_lshrrev_b32 v100, 16, v5
    v_lshl_add_u32 v105, v103, 7, v124
    v_mad_u32_u24 v103, v103, s68, v116
    v_add_u32 v100, 91024, v100
    s_branch L2_cont2
L2_half2:
    v_pk_mul_f32 v[20:21], v[36:37], v[40:41]
    v_pk_mul_f32 v[22:23], v[38:39], v[42:43]
    v_pk_mul_f32 v[24:25], v[52:53], v[40:41]
    v_pk_mul_f32 v[26:27], v[54:55], v[42:43]
    v_pk_fma_f32 v[24:25], v[56:57], v[36:37], v[24:25]
    v_pk_fma_f32 v[26:27], v[58:59], v[38:39], v[26:27]
    s_waitcnt vmcnt(4)
    v_mfma_f32_16x16x32_f16 v[28:31], v[112:115], v[60:63], v[8:11]
    v_rcp_f32 v20, v20
    v_rcp_f32 v21, v21
    v_rcp_f32 v22, v22
    v_rcp_f32 v23, v23
    ds_read_u16 v84, v100 offset:48
    ds_read_u16 v86, v100 offset:52
    v_pk_fma_f32 v[12:13], v[24:25], v[20:21], v[12:13]
    v_pk_fma_f32 v[14:15], v[26:27], v[22:23], v[14:15]
    s_waitcnt lgkmcnt(4)
    buffer_load_dwordx4 v[52:55], v[80:81], s[36:39], 0 idxen offen
    buffer_load_dwordx4 v[56:59], v[82:83], s[36:39], 0 idxen offen
    v_pk_fma_f32 v[28:29], v[96:97], v[120:121], v[28:29] op_sel_hi:[0,1,1]
    v_pk_fma_f32 v[30:31], v[96:97], v[122:123], v[30:31] op_sel_hi:[0,1,1]
    ds_read_u16_d16_hi v96, v100 offset:50
    ds_read_u16_d16_hi v97, v100 offset:54
    v_exp_f32_e64 v28, v28 clamp
    v_exp_f32_e64 v29, v29 clamp
    v_exp_f32_e64 v30, v30 clamp
    v_exp_f32_e64 v31, v31 clamp
    v_pk_add_f32 v[28:29], v[28:29], s[66:67]
    v_pk_add_f32 v[30:31], v[30:31], s[66:67]
    s_mov_b32 s61, 0
    s_mov_b32 s64, 0
    s_mov_b32 s57, 1
    s_branch L2_top3
L2_sw2:
    s_cmp_lg_u32 s57, 0
    s_cbranch_scc1 L2_swh2
    v_pk_mul_f32 v[20:21], v[36:37], v[40:41]
    v_pk_mul_f32 v[22:23], v[38:39], v[42:43]
    v_pk_mul_f32 v[24:25], v[52:53], v[40:41]
    v_pk_mul_f32 v[26:27], v[54:55], v[42:43]
    v_pk_fma_f32 v[24:25], v[56:57], v[36:37], v[24:25]
    v_pk_fma_f32 v[26:27], v[58:59], v[38:39], v[26:27]
    v_rcp_f32 v20, v20
    v_rcp_f32 v21, v21
    v_rcp_f32 v22, v22
    v_rcp_f32 v23, v23
    s_nop 0
    v_pk_fma_f32 v[12:13], v[24:25], v[20:21], v[12:13]
    v_pk_fma_f32 v[14:15], v[26:27], v[22:23], v[14:15]
    s_branch L2_swf2
L2_swh2:
    v_rcp_f32 v36, v36
    v_rcp_f32 v37, v37
    v_rcp_f32 v38, v38
    v_rcp_f32 v39, v39
    s_mov_b32 s57, 0
    v_pk_fma_f32 v[12:13], v[36:37], v[52:53], v[12:13]
    v_pk_fma_f32 v[14:15], v[38:39], v[54:55], v[14:15]
L2_swf2:
    s_cmp_lg_u32 s58, 0
    s_cbranch_scc1 L2_fin2
    v_pk_fma_f32 v[16:17], v[12:13], s[66:67], v[16:17]
    v_pk_fma_f32 v[18:19], v[14:15], s[66:67], v[18:19]
    ds_write_b128 v101, v[16:19] offset:33088
    ds_add_u32 v118, v119 offset:4
    s_branch L2_fld2
L2_fin2:
    s_cmp_lg_u32 s59, 0
    s_cbranch_scc1 L2_rdy2
    s_mov_b32 s25, 0
L2_spin2:
    v_mov_b32 v4, 0
    ds_read_b32 v4, v4 offset:5132
    s_waitcnt lgkmcnt(0)
    v_readfirstlane_b32 s24, v4
    s_nop 3
    s_cmp_ge_u32 s24, 25
    s_cbranch_scc1 L2_seen2
    s_sleep 2
    s_add_u32 s25, s25, 1
    s_cmp_lt_u32 s25, 0x400000
    s_cbranch_scc1 L2_spin2
L2_seen2:
    s_mov_b32 s59, 1
L2_rdy2:
    ds_read_b128 v[16:19], v101 offset:33088
    s_waitcnt lgkmcnt(0)
    v_pk_fma_f32 v[16:17], v[12:13], s[66:67], v[16:17]
    v_pk_fma_f32 v[18:19], v[14:15], s[66:67], v[18:19]
    v_pk_mul_f32 v[20:21], v[16:17], s[28:29]
    v_pk_mul_f32 v[22:23], v[18:19], s[28:29]
    v_exp_f32 v20, v20
    v_exp_f32 v21, v21
    v_exp_f32 v22, v22
    v_exp_f32 v23, v23
    v_pk_add_f32 v[20:21], v[20:21], s[30:31]
    v_pk_add_f32 v[22:23], v[22:23], s[30:31]
    v_rcp_f32 v20, v20
    v_rcp_f32 v21, v21
    v_rcp_f32 v22, v22
    v_rcp_f32 v23, v23
    v_pk_mul_f32 v[16:17], v[16:17], v[20:21]
    v_pk_mul_f32 v[18:19], v[18:19], v[22:23]
    v_cvt_pk_bf16_f32 v24, v16, v17
    v_cvt_pk_bf16_f32 v25, v18, v19
    global_store_dwordx2 v104, v[24:25], s[18:19] nt
L2_fld2:
    s_cmp_eq_u32 s62, 0
    s_cbranch_scc1 L2_exit
    ds_read_b128 v[8:11], v103 offset:5888
    ds_read_b128 v[16:19], v103 offset:33088
    v_mov_b32 v12, 0
    v_mov_b32 v13, 0
    v_mov_b32 v14, 0
    v_mov_b32 v15, 0
    v_mov_b32 v101, v103
    v_mov_b32 v104, v105
    s_cmp_ge_u32 s63, 25
    s_cselect_b32 s58, 1, 0
    s_and_b32 s69, s62, 1
    s_add_u32 s61, s62, 1
    s_lshr_b32 s61, s61, 1
    s_mov_b32 s64, 4
    s_cmp_lt_u32 s63, 38
    s_cbranch_scc1 L2_p1_2
    s_setprio 0
    s_branch L2_pd_2
L2_p1_2:
    s_cmp_lt_u32 s63, 25
    s_cbranch_scc1 L2_pd_2
    s_setprio 1
L2_pd_2:
    s_cmp_eq_u32 s61, 4
    s_cbranch_scc0 L2_sw2_2
    ds_add_rtn_u32 v4, v118, v119
    s_mov_b32 s64, s69
    s_waitcnt lgkmcnt(0)
    v_readfirstlane_b32 s63, v4
    s_mov_b32 s62, 0
    v_mov_b32 v100, 110224
    s_nop 1
    s_cmp_lt_u32 s63, 50
    s_cbranch_scc0 L2_sw2_2
    s_lshl_b32 s26, s63, 4
    v_add_u32 v4, s26, v117
    ds_read_b32 v5, v4 offset:4096
    v_readlane_b32 s62, v125, s63
    s_waitcnt lgkmcnt(0)
    v_and_b32 v103, 0xffff, v5
    v_lshrrev_b32 v100, 16, v5
    v_lshl_add_u32 v105, v103, 7, v124
    v_mad_u32_u24 v103, v103, s68, v116
    v_add_u32 v100, 91024, v100
    s_branch L2_sw2_2
L2_sw2_2:
    s_waitcnt vmcnt(4) lgkmcnt(0)
    v_mfma_f32_16x16x32_f16 v[28:31], v[112:115], v[60:63], v[8:11]
    v_mfma_f32_16x16x32_f16 v[32:35], v[112:115], v[64:67], v[8:11]
    ds_read_u16 v84, v100 offset:48
    ds_read_u16 v86, v100 offset:52
    s_nop 2
    buffer_load_dwordx4 v[52:55], v[80:81], s[36:39], 0 idxen offen
    buffer_load_dwordx4 v[56:59], v[82:83], s[36:39], 0 idxen offen
    s_branch L2_mid2
L2_ev3:
    s_cmp_eq_u32 s64, 0
    s_cbranch_scc1 L2_sw3
    s_cmp_eq_u32 s64, 1
    s_cbranch_scc1 L2_half3
    ds_add_rtn_u32 v4, v118, v119
    s_mov_b32 s64, s69
    s_waitcnt lgkmcnt(0)
    v_readfirstlane_b32 s63, v4
    s_mov_b32 s62, 0
    v_mov_b32 v100, 110216
    s_nop 1
    s_cmp_lt_u32 s63, 50
    s_cbranch_scc0 L2_cont3
    s_lshl_b32 s26, s63, 4
    v_add_u32 v4, s26, v117
    ds_read_b32 v5, v4 offset:4096
    v_readlane_b32 s62, v125, s63
    s_waitcnt lgkmcnt(0)
    v_and_b32 v103, 0xffff, v5
    v_lshrrev_b32 v100, 16, v5
    v_lshl_add_u32 v105, v103, 7, v124
    v_mad_u32_u24 v103, v103, s68, v116
    v_add_u32 v100, 91016, v100
    s_branch L2_cont3
L2_half3:
    v_pk_mul_f32 v[20:21], v[28:29], v[32:33]
    v_pk_mul_f32 v[22:23], v[30:31], v[34:35]
    v_pk_mul_f32 v[24:25], v[60:61], v[32:33]
    v_pk_mul_f32 v[26:27], v[62:63], v[34:35]
    v_pk_fma_f32 v[24:25], v[64:65], v[28:29], v[24:25]
    v_pk_fma_f32 v[26:27], v[66:67], v[30:31], v[26:27]
    s_waitcnt vmcnt(4)
    v_mfma_f32_16x16x32_f16 v[36:39], v[112:115], v[68:71], v[8:11]
    v_rcp_f32 v20, v20
    v_rcp_f32 v21, v21
    v_rcp_f32 v22, v22
    v_rcp_f32 v23, v23
    ds_read_u16 v88, v100 offset:56
    ds_read_u16 v90, v100 offset:60
    v_pk_fma_f32 v[12:13], v[24:25], v[20:21], v[12:13]
    v_pk_fma_f32 v[14:15], v[26:27], v[22:23], v[14:15]
    s_waitcnt lgkmcnt(4)
    buffer_load_dwordx4 v[60:63], v[84:85], s[36:39], 0 idxen offen
    buffer_load_dwordx4 v[64:67], v[86:87], s[36:39], 0 idxen offen
    v_pk_fma_f32 v[36:37], v[98:99], v[120:121], v[36:37] op_sel_hi:[0,1,1]
    v_pk_fma_f32 v[38:39], v[98:99], v[122:123], v[38:39] op_sel_hi:[0,1,1]
    ds_read_u16_d16_hi v98, v100 offset:58
    ds_read_u16_d16_hi v99, v100 offset:62
    v_exp_f32_e64 v36, v36 clamp
    v_exp_f32_e64 v37, v37 clamp
    v_exp_f32_e64 v38, v38 clamp
    v_exp_f32_e64 v39, v39 clamp
    v_pk_add_f32 v[36:37], v[36:37], s[66:67]
    v_pk_add_f32 v[38:39], v[38:39], s[66:67]
    s_mov_b32 s61, 0
    s_mov_b32 s64, 0
    s_mov_b32 s57, 1
    v_add_u32 v100, 32, v100
    s_branch L2_top0
L2_sw3:
    s_cmp_lg_u32 s57, 0
    s_cbranch_scc1 L2_swh3
    v_pk_mul_f32 v[20:21], v[28:29], v[32:33]
    v_pk_mul_f32 v[22:23], v[30:31], v[34:35]
    v_pk_mul_f32 v[24:25], v[60:61], v[32:33]
    v_pk_mul_f32 v[26:27], v[62:63], v[34:35]
    v_pk_fma_f32 v[24:25], v[64:65], v[28:29], v[24:25]
    v_pk_fma_f32 v[26:27], v[66:67], v[30:31], v[26:27]
    v_rcp_f32 v20, v20
    v_rcp_f32 v21, v21
    v_rcp_f32 v22, v22
    v_rcp_f32 v23, v23
    s_nop 0
    v_pk_fma_f32 v[12:13], v[24:25], v[20:21], v[12:13]
    v_pk_fma_f32 v[14:15], v[26:27], v[22:23], v[14:15]
    s_branch L2_swf3
L2_swh3:
    v_rcp_f32 v28, v28
    v_rcp_f32 v29, v29
    v_rcp_f32 v30, v30
    v_rcp_f32 v31, v31
    s_mov_b32 s57, 0
    v_pk_fma_f32 v[12:13], v[28:29], v[60:61], v[12:13]
    v_pk_fma_f32 v[14:15], v[30:31], v[62:63], v[14:15]
L2_swf3:
    s_cmp_lg_u32 s58, 0
    s_cbranch_scc1 L2_fin3
    v_pk_fma_f32 v[16:17], v[12:13], s[66:67], v[16:17]
    v_pk_fma_f32 v[18:19], v[14:15], s[66:67], v[18:19]
    ds_write_b128 v101, v[16:19] offset:33088
    ds_add_u32 v118, v119 offset:4
    s_branch L2_fld3
L2_fin3:
    s_cmp_lg_u32 s59, 0
    s_cbranch_scc1 L2_rdy3
    s_mov_b32 s25, 0
L2_spin3:
    v_mov_b32 v4, 0
    ds_read_b32 v4, v4 offset:5132
    s_waitcnt lgkmcnt(0)
    v_readfirstlane_b32 s24, v4
    s_nop 3
    s_cmp_ge_u32 s24, 25
    s_cbranch_scc1 L2_seen3
    s_sleep 2
    s_add_u32 s25, s25, 1
    s_cmp_lt_u32 s25, 0x400000
    s_cbranch_scc1 L2_spin3
L2_seen3:
    s_mov_b32 s59, 1
L2_rdy3:
    ds_read_b128 v[16:19], v101 offset:33088
    s_waitcnt lgkmcnt(0)
    v_pk_fma_f32 v[16:17], v[12:13], s[66:67], v[16:17]
    v_pk_fma_f32 v[18:19], v[14:15], s[66:67], v[18:19]
    v_pk_mul_f32 v[20:21], v[16:17], s[28:29]
    v_pk_mul_f32 v[22:23], v[18:19], s[28:29]
    v_exp_f32 v20, v20
    v_exp_f32 v21, v21
    v_exp_f32 v22, v22
    v_exp_f32 v23, v23
    v_pk_add_f32 v[20:21], v[20:21], s[30:31]
    v_pk_add_f32 v[22:23], v[22:23], s[30:31]
    v_rcp_f32 v20, v20
    v_rcp_f32 v21, v21
    v_rcp_f32 v22, v22
    v_rcp_f32 v23, v23
    v_pk_mul_f32 v[16:17], v[16:17], v[20:21]
    v_pk_mul_f32 v[18:19], v[18:19], v[22:23]
    v_cvt_pk_bf16_f32 v24, v16, v17
    v_cvt_pk_bf16_f32 v25, v18, v19
    global_store_dwordx2 v104, v[24:25], s[18:19] nt
L2_fld3:
    s_cmp_eq_u32 s62, 0
    s_cbranch_scc1 L2_exit
    ds_read_b128 v[8:11], v103 offset:5888
    ds_read_b128 v[16:19], v103 offset:33088
    v_mov_b32 v12, 0
    v_mov_b32 v13, 0
    v_mov_b32 v14, 0
    v_mov_b32 v15, 0
    v_mov_b32 v101, v103
    v_mov_b32 v104, v105
    s_cmp_ge_u32 s63, 25
    s_cselect_b32 s58, 1, 0
    s_and_b32 s69, s62, 1
    s_add_u32 s61, s62, 1
    s_lshr_b32 s61, s61, 1
    s_mov_b32 s64, 4
    s_cmp_lt_u32 s63, 38
    s_cbranch_scc1 L2_p1_3
    s_setprio 0
    s_branch L2_pd_3
L2_p1_3:
    s_cmp_lt_u32 s63, 25
    s_cbranch_scc1 L2_pd_3
    s_setprio 1
L2_pd_3:
    s_cmp_eq_u32 s61, 4
    s_cbranch_scc0 L2_sw2_3
    ds_add_rtn_u32 v4, v118, v119
    s_mov_b32 s64, s69
    s_waitcnt lgkmcnt(0)
    v_readfirstlane_b32 s63, v4
    s_mov_b32 s62, 0
    v_mov_b32 v100, 110216
    s_nop 1
    s_cmp_lt_u32 s63, 50
    s_cbranch_scc0 L2_sw2_3
    s_lshl_b32 s26, s63, 4
    v_add_u32 v4, s26, v117
    ds_read_b32 v5, v4 offset:4096
    v_readlane_b32 s62, v125, s63
    s_waitcnt lgkmcnt(0)
    v_and_b32 v103, 0xffff, v5
    v_lshrrev_b32 v100, 16, v5
    v_lshl_add_u32 v105, v103, 7, v124
    v_mad_u32_u24 v103, v103, s68, v116
    v_add_u32 v100, 91016, v100
    s_branch L2_sw2_3
L2_sw2_3:
    s_waitcnt vmcnt(4) lgkmcnt(0)
    v_mfma_f32_16x16x32_f16 v[36:39], v[112:115], v[68:71], v[8:11]
    v_mfma_f32_16x16x32_f16 v[40:43], v[112:115], v[72:75], v[8:11]
    ds_read_u16 v88, v100 offset:56
    ds_read_u16 v90, v100 offset:60
    s_nop 2
    buffer_load_dwordx4 v[60:63], v[84:85], s[36:39], 0 idxen offen
    buffer_load_dwordx4 v[64:67], v[86:87], s[36:39], 0 idxen offen
    s_branch L2_mid3
L2_exit:
    s_endpgm
L2_slow:
    v_lshlrev_b32 v2, 2, v1
    v_lshlrev_b32 v3, 1, v1
    v_add_u32 v3, 16384, v3
    global_load_ushort v4, v3, s[16:17]
    s_mov_b32 s24, 0xbfb8aa3b
    s_waitcnt vmcnt(0) lgkmcnt(0)
    v_lshlrev_b32 v4, 16, v4
    v_mul_f32 v8, s24, v4
    s_mov_b32 s61, 0
L2_slow_seg:
    s_cmp_ge_u32 s61, 250
    s_cbranch_scc1 L2_done
    s_lshl_b32 s24, s61, 8
    s_add_u32 s24, s24, s2
    s_lshl_b32 s24, s24, 2
    s_add_u32 s24, s24, 14680064
    v_mov_b32 v3, s24
    global_load_dword v4, v3, s[20:21]
    s_waitcnt vmcnt(0)
    v_readfirstlane_b32 s25, v4
    s_nop 3
    s_lshr_b32 s62, s25, 16
    s_and_b32 s25, s25, 0xffff
    s_mul_i32 s26, s61, 3200
    s_add_u32 s26, s26, s25
    s_lshl_b32 s26, s26, 3
    s_add_u32 s63, s26, 7340032
L2_slow_rec:
    s_cmp_eq_u32 s62, 0
    s_cbranch_scc1 L2_slow_next
    v_cmp_gt_u32 vcc, s62, v1
    v_lshlrev_b32 v20, 3, v1
    v_add_u32 v20, s63, v20
    s_and_saveexec_b64 s[40:41], vcc
    global_load_dwordx2 v[22:23], v20, s[20:21]
    s_mov_b64 exec, s[40:41]
    s_mov_b64 s[42:43], vcc
    s_add_u32 s63, s63, 512
    s_min_u32 s25, s62, 64
    s_sub_u32 s62, s62, s25
    s_waitcnt vmcnt(0)
    v_and_b32 v21, 15, v23
    v_cmp_eq_u32 vcc, s22, v21
    s_nop 1
    s_and_b64 s[42:43], s[42:43], vcc
L2_slow_edge:
    s_cmp_eq_u64 s[42:43], 0
    s_cbranch_scc1 L2_slow_rec
    s_ff1_i32_b64 s24, s[42:43]
    s_bitset0_b64 s[42:43], s24
    v_readlane_b32 s25, v22, s24
    v_readlane_b32 s26, v23, s24
    s_nop 1
    s_and_b32 s27, s25, 0xffff
    s_and_b32 s25, s25, 0xffff0000
    s_and_b32 s26, s26, 127
    s_mul_i32 s26, s26, 272
    v_mov_b32 v18, s27
    v_mov_b32 v19, v2
    buffer_load_dword v13, v[18:19], s[36:39], 0 idxen offen
    v_add_u32 v14, s26, v2
    ds_read_b32 v15, v14 offset:5888
    ds_read_b32 v17, v14 offset:33088
    s_waitcnt vmcnt(0) lgkmcnt(0)
    v_cvt_f32_f16 v16, v13
    v_add_f32 v16, v16, v15
    v_fmac_f32 v16, s25, v8
    v_exp_f32 v16, v16
    s_mov_b32 s25, 0x21800000
    v_add_f32 v16, s25, v16
    v_rcp_f32 v16, v16
    s_nop 0
    v_mul_f32 v16, s25, v16
    v_fmac_f32 v17, v16, v13
    ds_write_b32 v14, v17 offset:33088
    s_waitcnt lgkmcnt(0)
    s_branch L2_slow_edge
L2_slow_next:
    s_add_u32 s61, s61, 1
    s_branch L2_slow_seg
L2_done:
    s_setprio 0
    v_lshrrev_b32 v2, 4, v0
    v_and_b32 v3, 15, v0
    v_mul_u32_u24 v4, 272, v2
    v_lshl_add_u32 v4, v3, 4, v4
    s_mul_i32 s24, s2, 12800
    v_lshlrev_b32 v5, 7, v2
    v_lshl_add_u32 v5, v3, 3, v5
    v_add_u32 v5, s24, v5
    v_add_u32 v7, 17408, v4
    v_add_u32 v6, 8192, v5
    s_mov_b32 s24, 0xbfb8aa3b
    s_mov_b32 s25, 0xbfb8aa3b
    s_mov_b32 s26, 1.0
    s_mov_b32 s27, 1.0
    s_waitcnt vmcnt(0) lgkmcnt(0)
    s_barrier
    ds_read_b128 v[8:11], v4 offset:33088
    s_cmp_lt_u32 s22, 9
    s_cbranch_scc0 L2_ep1
    ds_read_b128 v[16:19], v7 offset:33088
    s_waitcnt lgkmcnt(0)
    v_pk_mul_f32 v[20:21], v[16:17], s[24:25]
    v_pk_mul_f32 v[22:23], v[18:19], s[24:25]
    v_exp_f32 v20, v20
    v_exp_f32 v21, v21
    v_exp_f32 v22, v22
    v_exp_f32 v23, v23
    v_pk_add_f32 v[20:21], v[20:21], s[26:27]
    v_pk_add_f32 v[22:23], v[22:23], s[26:27]
    v_rcp_f32 v20, v20
    v_rcp_f32 v21, v21
    v_rcp_f32 v22, v22
    v_rcp_f32 v23, v23
    v_pk_mul_f32 v[16:17], v[16:17], v[20:21]
    v_pk_mul_f32 v[18:19], v[18:19], v[22:23]
    v_cvt_pk_bf16_f32 v20, v16, v17
    v_cvt_pk_bf16_f32 v21, v18, v19
    global_store_dwordx2 v6, v[20:21], s[18:19] nt
L2_ep1:
    s_waitcnt lgkmcnt(0)
    v_pk_mul_f32 v[12:13], v[8:9], s[24:25]
    v_pk_mul_f32 v[14:15], v[10:11], s[24:25]
    v_exp_f32 v12, v12
    v_exp_f32 v13, v13
    v_exp_f32 v14, v14
    v_exp_f32 v15, v15
    v_pk_add_f32 v[12:13], v[12:13], s[26:27]
    v_pk_add_f32 v[14:15], v[14:15], s[26:27]
    v_rcp_f32 v12, v12
    v_rcp_f32 v13, v13
    v_rcp_f32 v14, v14
    v_rcp_f32 v15, v15
    v_pk_mul_f32 v[8:9], v[8:9], v[12:13]
    v_pk_mul_f32 v[10:11], v[10:11], v[14:15]
    v_cvt_pk_bf16_f32 v12, v8, v9
    v_cvt_pk_bf16_f32 v13, v10, v11
    global_store_dwordx2 v5, v[12:13], s[18:19] nt
L2_end:
    s_endpgm
    .section .rodata,"a"
    .p2align 6
    .amdhsa_kernel egc_part_kernel
    .amdhsa_next_free_vgpr 112
    .amdhsa_next_free_sgpr 80
    .amdhsa_accum_offset 112
    .amdhsa_group_segment_fixed_size 0
    .amdhsa_kernarg_size 80
    .amdhsa_user_sgpr_count 2
    .amdhsa_user_sgpr_kernarg_segment_ptr 1
    .amdhsa_system_sgpr_workgroup_id_x 1
    .amdhsa_float_denorm_mode_32 3
    .end_amdhsa_kernel
    .p2align 6
    .amdhsa_kernel standalone__edge_featured_mpnn_egc__graph_kernel
    .amdhsa_next_free_vgpr 128
    .amdhsa_next_free_sgpr 80
    .amdhsa_accum_offset 128
    .amdhsa_group_segment_fixed_size 0
    .amdhsa_kernarg_size 80
    .amdhsa_user_sgpr_count 2
    .amdhsa_user_sgpr_kernarg_segment_ptr 1
    .amdhsa_system_sgpr_workgroup_id_x 1
    .amdhsa_float_denorm_mode_32 3
    .end_amdhsa_kernel
```
